```python
import torch

def _softmax(x, axis=-1):
    return torch.softmax(x, dim=axis)
def _gelu(x):
    return torch.nn.functional.gelu(x, approximate="tanh")
def _silu(x):
    return torch.nn.functional.silu(x)
def _sigmoid(x):
    return torch.sigmoid(x)
def _layernorm(x, axis=-1, eps=1e-5):
    m = x.mean(dim=axis, keepdim=True)
    v = x.var(dim=axis, keepdim=True, unbiased=False)
    return (x - m) / torch.sqrt(v + eps)
def _scatter_add(tgt, idx, src, axis=0):
    return tgt.clone().index_add_(axis, idx, src)
def _segment_sum(src, seg, n):
    out = torch.zeros((n,) + src.shape[1:], dtype=src.dtype)
    return out.index_add_(0, seg, src)
def _pad(x, pw):
    flat = tuple(v for pair in reversed(pw) for v in pair)
    return torch.nn.functional.pad(x, flat)

kernel_name = 'standalone__dense_activation_squared_relu__prompt'

def setup_inputs():

    _w = (lambda a: (lambda t: t.to(torch.bfloat16) if t.is_floating_point() else t)(torch.as_tensor(a)))
    B, S, D, F = 1, 2048, 576, 4608
    return {
        "x": _w((lambda *s: torch.randn(*s, dtype=torch.bfloat16) * 0.05)(B, S, D)),
        "w1": _w((lambda *s: torch.randn(*s, dtype=torch.bfloat16) * 0.05)(D, F)),
        "b1": _w((lambda *s: torch.randn(*s, dtype=torch.bfloat16) * 0.05)(F)),
        "w2": _w((lambda *s: torch.randn(*s, dtype=torch.bfloat16) * 0.05)(F, D)),
        "b2": _w((lambda *s: torch.randn(*s, dtype=torch.bfloat16) * 0.05)(D)),
    }

def reference(x, w1, b1, w2, b2):
    h = torch.einsum("bsd,df->bsf", x, w1) + b1
    zero = torch.zeros_like(h)
    r = torch.where(h > zero, h, zero)
    h = r * r
    out = torch.einsum("bsf,fd->bsd", h, w2) + b2
    return out
```

```asm
; @launch grid=(256,1,1) block=(256,1,1) lds=163840
.amdgcn_target "amdgcn-amd-amdhsa--gfx950"
.text
.globl standalone__dense_activation_squared_relu__prompt_kernel
.p2align 8
.type standalone__dense_activation_squared_relu__prompt_kernel,@function
standalone__dense_activation_squared_relu__prompt_kernel:
    s_cmp_ge_u32 s2, 256
    s_cbranch_scc1 L_end
    s_load_dwordx16 s[64:79], s[0:1], 0
    s_getpc_b64 s[90:91]
L_pc:
    v_lshlrev_b32 v53, 7, v0
    v_min_u32 v54, L_code_end-L_pc-4, v53
    global_load_dword v255, v54, s[90:91]
    v_add_u32 v53, 32768, v53
    v_min_u32 v54, L_code_end-L_pc-4, v53
    global_load_dword v255, v54, s[90:91]
    s_and_b32 s84, s2, 7
    s_lshr_b32 s85, s2, 3
    v_lshrrev_b32 v53, 6, v0
    v_and_b32 v1, 63, v0
    s_and_b32 s32, s84, 3
    v_readfirstlane_b32 s28, v53
    s_lshr_b32 s86, s84, 2
    s_lshr_b32 s87, s85, 2
    s_and_b32 s33, s85, 3
    s_lshl_b32 s86, s86, 3
    s_add_u32 s29, s86, s87
    s_lshl_b32 s30, s32, 2
    s_add_u32 s30, s30, s33
    s_and_b32 s31, s33, 1
    s_lshl_b32 s84, s33, 1
    s_add_u32 s84, s84, s87
    s_cmp_ge_u32 s84, 9
    s_cselect_b32 s85, 9, 0
    s_sub_u32 s84, s84, s85
    s_mov_b32 s88, s84
    s_mul_i32 s89, s29, 147456
    s_mul_i32 s44, s84, 589824
    s_lshl_b32 s86, s84, 7
    s_add_u32 s53, s89, s86
    s_mul_i32 s34, s30, 576
    s_mul_i32 s41, s31, 320
    s_add_u32 s35, s34, 256
    s_add_u32 s34, s34, s41
    s_lshl_b32 s41, s31, 8
    s_sub_u32 s35, s35, s41
    s_lshl_b32 s39, s28, 12
    s_mul_i32 s38, s28, 5120
    s_mul_i32 s41, s28, 36864
    v_lshrrev_b32 v53, 3, v1
    v_lshrrev_b32 v54, 4, v1
    v_and_b32 v55, 7, v1
    v_mul_u32_u24 v53, 1152, v53
    v_add_u32 v53, s41, v53
    v_add_u32 v56, 0, v54
    v_and_b32 v56, 7, v56
    v_xor_b32 v56, v55, v56
    v_lshl_add_u32 v56, v56, 4, v53
    v_add_u32 v11, 0, v56
    v_add_u32 v56, 4, v54
    v_and_b32 v56, 7, v56
    v_xor_b32 v56, v55, v56
    v_lshl_add_u32 v56, v56, 4, v53
    v_add_u32 v12, 8192, v56
    v_add_u32 v56, 8, v54
    v_and_b32 v56, 7, v56
    v_xor_b32 v56, v55, v56
    v_lshl_add_u32 v56, v56, 4, v53
    v_add_u32 v13, 16384, v56
    v_add_u32 v56, 12, v54
    v_and_b32 v56, 7, v56
    v_xor_b32 v56, v55, v56
    v_lshl_add_u32 v56, v56, 4, v53
    v_add_u32 v14, 24576, v56
    s_mul_i32 s41, s28, 147456
    v_and_b32 v55, 15, v1
    v_mul_u32_u24 v53, 9216, v54
    v_add_u32 v53, s41, v53
    v_lshlrev_b32 v56, 1, v54
    v_xor_b32 v56, v55, v56
    v_xor_b32 v57, 8, v56
    v_lshl_add_u32 v2, v56, 4, v53
    v_lshl_add_u32 v57, v57, 4, v53
    v_add_u32 v3, 35840, v2
    v_add_u32 v4, 71680, v57
    v_add_u32 v5, 107520, v57
    v_lshlrev_b32 v48, 3, v54
    v_lshlrev_b32 v57, 4, v1
    v_mov_b32 v56, 1073741824
    v_cmp_gt_u32 vcc, 36, v1
    s_mul_i32 s86, s30, 576
    s_mul_i32 s87, s33, 288
    v_cndmask_b32 v58, v56, v57, vcc
    v_cmp_gt_u32 vcc, 18, v1
    s_nop 1
    v_cndmask_b32 v59, v56, v57, vcc
    s_waitcnt lgkmcnt(0)
    s_mov_b32 s4, s64
    s_mov_b32 s5, s65
    s_mov_b32 s6, 2359296
    s_mov_b32 s7, 0x20000
    s_mov_b32 s8, s66
    s_mov_b32 s9, s67
    s_mov_b32 s10, 5308416
    s_mov_b32 s11, 0x20000
    s_mov_b32 s12, s68
    s_mov_b32 s13, s69
    s_mov_b32 s14, 9216
    s_mov_b32 s15, 0x20000
    s_mov_b32 s92, s72
    s_mov_b32 s93, s73
    s_mov_b32 s94, 1152
    s_mov_b32 s95, 0x20000
    s_mov_b32 m0, 98304
    s_nop 0
    buffer_load_dwordx4 v58, s[12:15], s86 offen lds
    s_mov_b32 m0, 99328
    s_nop 0
    buffer_load_dwordx4 v59, s[92:95], s87 offen lds
    s_add_u32 m0, s39, 102400
    s_nop 0
    buffer_load_dwordx4 v11, s[4:7], s53 offen offset:0 lds
    buffer_load_dwordx4 v12, s[4:7], s53 offen offset:1024 lds
    buffer_load_dwordx4 v13, s[4:7], s53 offen offset:2048 lds
    buffer_load_dwordx4 v14, s[4:7], s53 offen offset:3072 lds
    s_add_u32 s36, s34, s44
    s_add_u32 m0, s39, 0
    s_nop 0
    buffer_load_dwordx4 v2, s[8:11], s36 offen offset:0 lds
    buffer_load_dwordx4 v3, s[8:11], s36 offen offset:1024 lds
    buffer_load_dwordx4 v4, s[8:11], s36 offen offset:2048 lds
    buffer_load_dwordx4 v5, s[8:11], s36 offen offset:3072 lds
    s_mov_b32 s16, s78
    s_mov_b32 s17, s79
    s_mov_b32 s18, 268435456
    s_mov_b32 s19, 0x20000
    s_mov_b32 s20, s70
    s_mov_b32 s21, s71
    s_mov_b32 s22, 5308416
    s_mov_b32 s23, 0x20000
    s_mov_b32 s24, s74
    s_mov_b32 s25, s75
    s_mov_b32 s26, 2359296
    s_mov_b32 s27, 0x20000
    s_mov_b32 s100, s76
    s_mov_b32 s101, s77
    s_nop 0
    s_add_u32 s88, s88, 1
    s_cmp_eq_u32 s88, 9
    s_cselect_b32 s88, 0, s88
    s_mul_i32 s45, s88, 589824
    s_lshl_b32 s84, s88, 7
    s_add_u32 s54, s89, s84
    s_add_u32 s88, s88, 1
    s_cmp_eq_u32 s88, 9
    s_cselect_b32 s88, 0, s88
    s_mul_i32 s46, s88, 589824
    s_lshl_b32 s84, s88, 7
    s_add_u32 s55, s89, s84
    s_add_u32 s88, s88, 1
    s_cmp_eq_u32 s88, 9
    s_cselect_b32 s88, 0, s88
    s_mul_i32 s47, s88, 589824
    s_lshl_b32 s84, s88, 7
    s_add_u32 s56, s89, s84
    s_add_u32 s88, s88, 1
    s_cmp_eq_u32 s88, 9
    s_cselect_b32 s88, 0, s88
    s_mul_i32 s48, s88, 589824
    s_lshl_b32 s84, s88, 7
    s_add_u32 s57, s89, s84
    s_add_u32 s88, s88, 1
    s_cmp_eq_u32 s88, 9
    s_cselect_b32 s88, 0, s88
    s_mul_i32 s49, s88, 589824
    s_lshl_b32 s84, s88, 7
    s_add_u32 s58, s89, s84
    s_add_u32 s88, s88, 1
    s_cmp_eq_u32 s88, 9
    s_cselect_b32 s88, 0, s88
    s_mul_i32 s50, s88, 589824
    s_lshl_b32 s84, s88, 7
    s_add_u32 s59, s89, s84
    s_add_u32 s88, s88, 1
    s_cmp_eq_u32 s88, 9
    s_cselect_b32 s88, 0, s88
    s_mul_i32 s51, s88, 589824
    s_lshl_b32 s84, s88, 7
    s_add_u32 s60, s89, s84
    s_add_u32 s88, s88, 1
    s_cmp_eq_u32 s88, 9
    s_cselect_b32 s88, 0, s88
    s_mul_i32 s52, s88, 589824
    s_lshl_b32 s84, s88, 7
    s_add_u32 s61, s89, s84
    v_lshrrev_b32 v53, 4, v1
    v_and_b32 v54, 1, v53
    v_lshrrev_b32 v55, 1, v53
    v_and_b32 v56, 15, v1
    v_lshrrev_b32 v57, 2, v56
    v_and_b32 v56, 3, v56
    v_lshl_add_u32 v40, v54, 3, v57
    v_lshlrev_b32 v41, 8, v40
    v_lshl_add_u32 v41, v55, 12, v41
    v_lshl_add_u32 v41, v56, 3, v41
    v_lshl_add_u32 v20, v54, 2, v57
    v_lshl_add_u32 v41, v20, 5, v41
    v_xor_b32 v20, 0, v41
    v_xor_b32 v21, 32, v41
    v_xor_b32 v22, 64, v41
    v_xor_b32 v23, 96, v41
    v_xor_b32 v24, 128, v41
    v_xor_b32 v25, 160, v41
    v_xor_b32 v26, 192, v41
    v_xor_b32 v27, 224, v41
    v_add_u32 v28, 61440, v20
    v_add_u32 v29, 61440, v21
    v_add_u32 v30, 61440, v22
    v_add_u32 v31, 61440, v23
    v_add_u32 v32, 61440, v24
    v_add_u32 v33, 61440, v25
    v_add_u32 v34, 61440, v26
    v_add_u32 v35, 61440, v27
    v_and_b32 v53, 15, v1
    v_lshrrev_b32 v54, 4, v1
    v_lshrrev_b32 v55, 1, v53
    v_xor_b32 v54, v54, v55
    v_lshlrev_b32 v54, 4, v54
    v_lshl_add_u32 v54, v53, 7, v54
    v_add_u32 v54, 102400, v54
    v_add_u32 v45, s39, v54
    v_xor_b32 v54, 64, v54
    v_add_u32 v46, s39, v54
    s_mul_i32 s84, s28, 147456
    v_add_u32 v56, 0, v1
    v_mul_u32_u24 v57, 205, v56
    v_lshrrev_b32 v57, 12, v57
    v_mul_u32_u24 v58, 20, v57
    v_sub_u32 v58, v56, v58
    v_lshrrev_b32 v59, 2, v57
    v_and_b32 v59, 2, v59
    v_xor_b32 v58, v58, v59
    v_mul_u32_u24 v59, 9216, v57
    v_lshl_add_u32 v59, v58, 4, v59
    v_add_u32 v6, s84, v59
    v_add_u32 v56, 64, v1
    v_mul_u32_u24 v57, 205, v56
    v_lshrrev_b32 v57, 12, v57
    v_mul_u32_u24 v58, 20, v57
    v_sub_u32 v58, v56, v58
    v_lshrrev_b32 v59, 2, v57
    v_and_b32 v59, 2, v59
    v_xor_b32 v58, v58, v59
    v_mul_u32_u24 v59, 9216, v57
    v_lshl_add_u32 v59, v58, 4, v59
    v_add_u32 v7, s84, v59
    v_subrev_u32 v7, 1024, v7
    v_add_u32 v56, 128, v1
    v_mul_u32_u24 v57, 205, v56
    v_lshrrev_b32 v57, 12, v57
    v_mul_u32_u24 v58, 20, v57
    v_sub_u32 v58, v56, v58
    v_lshrrev_b32 v59, 2, v57
    v_and_b32 v59, 2, v59
    v_xor_b32 v58, v58, v59
    v_mul_u32_u24 v59, 9216, v57
    v_lshl_add_u32 v59, v58, 4, v59
    v_add_u32 v8, s84, v59
    v_subrev_u32 v8, 2048, v8
    v_add_u32 v56, 192, v1
    v_mul_u32_u24 v57, 205, v56
    v_lshrrev_b32 v57, 12, v57
    v_mul_u32_u24 v58, 20, v57
    v_sub_u32 v58, v56, v58
    v_lshrrev_b32 v59, 2, v57
    v_and_b32 v59, 2, v59
    v_xor_b32 v58, v58, v59
    v_mul_u32_u24 v59, 9216, v57
    v_lshl_add_u32 v59, v58, 4, v59
    v_add_u32 v9, s84, v59
    v_subrev_u32 v9, 3072, v9
    v_add_u32 v56, 256, v1
    v_mul_u32_u24 v57, 205, v56
    v_lshrrev_b32 v57, 12, v57
    v_mul_u32_u24 v58, 20, v57
    v_sub_u32 v58, v56, v58
    v_lshrrev_b32 v59, 2, v57
    v_and_b32 v59, 2, v59
    v_xor_b32 v58, v58, v59
    v_mul_u32_u24 v59, 9216, v57
    v_lshl_add_u32 v59, v58, 4, v59
    v_add_u32 v10, s84, v59
    s_lshl_b32 s84, s28, 11
    s_lshl_b32 s85, s29, 4
    s_add_u32 s85, s85, s30
    s_mul_i32 s40, s85, 73728
    v_lshl_add_u32 v47, v1, 4, s84
    s_lshl_b32 s85, s85, 7
    s_add_u32 s85, s85, 41943040
    v_mov_b32 v56, s85
    v_mov_b32 v57, 1073741824
    v_cmp_eq_u32 vcc, 0, v1
    s_nop 1
    v_cndmask_b32 v50, v57, v56, vcc
    v_lshrrev_b32 v56, 4, v1
    v_and_b32 v57, 1, v56
    v_lshrrev_b32 v58, 1, v56
    v_and_b32 v59, 15, v1
    v_lshrrev_b32 v60, 2, v59
    v_and_b32 v59, 3, v59
    v_lshl_add_u32 v40, v57, 3, v60
    v_mul_u32_u24 v40, 320, v40
    v_mul_u32_u24 v41, 5120, v58
    v_add_u32 v40, v40, v41
    v_lshl_add_u32 v40, v59, 3, v40
    v_lshlrev_b32 v57, 5, v57
    v_add_u32 v36, v40, v57
    v_sub_u32 v37, v40, v57
    v_add_u32 v38, 61440, v36
    v_add_u32 v39, 61440, v37
    v_add_u32 v40, 122880, v36
    v_add_u32 v41, 122880, v37
    v_lshl_add_u32 v60, v56, 2, v60
    v_mul_u32_u24 v60, 288, v60
    v_lshl_add_u32 v42, v59, 3, v60
    v_add_u32 v43, 61440, v42
    v_add_u32 v44, 122880, v42
    s_lshl_b32 s85, s29, 2
    s_add_u32 s85, s85, s32
    s_lshl_b32 s85, s85, 9
    s_add_u32 s85, s85, 41943040
    v_and_b32 v56, 3, v1
    v_min_u32 v56, 2, v56
    v_add_u32 v56, 1, v56
    v_add_u32 v56, s33, v56
    v_and_b32 v56, 3, v56
    v_lshlrev_b32 v56, 7, v56
    v_add_u32 v49, s85, v56
    s_and_b32 s84, s28, 1
    s_mul_i32 s84, s84, 18432
    v_add_u32 v56, 0, v1
    v_mul_u32_u24 v57, 57, v56
    v_lshrrev_b32 v57, 10, v57
    v_mul_u32_u24 v58, 18, v57
    v_sub_u32 v58, v56, v58
    v_mul_u32_u24 v59, 1152, v57
    v_lshl_add_u32 v59, v58, 4, v59
    v_add_u32 v15, s84, v59
    v_add_u32 v56, 64, v1
    v_mul_u32_u24 v57, 57, v56
    v_lshrrev_b32 v57, 10, v57
    v_mul_u32_u24 v58, 18, v57
    v_sub_u32 v58, v56, v58
    v_mul_u32_u24 v59, 1152, v57
    v_lshl_add_u32 v59, v58, 4, v59
    v_add_u32 v16, s84, v59
    v_subrev_u32 v16, 1024, v16
    v_add_u32 v56, 128, v1
    v_mul_u32_u24 v57, 57, v56
    v_lshrrev_b32 v57, 10, v57
    v_mul_u32_u24 v58, 18, v57
    v_sub_u32 v58, v56, v58
    v_mul_u32_u24 v59, 1152, v57
    v_lshl_add_u32 v59, v58, 4, v59
    v_add_u32 v17, s84, v59
    v_subrev_u32 v17, 2048, v17
    v_add_u32 v56, 192, v1
    v_mul_u32_u24 v57, 57, v56
    v_lshrrev_b32 v57, 10, v57
    v_mul_u32_u24 v58, 18, v57
    v_sub_u32 v58, v56, v58
    v_mul_u32_u24 v59, 1152, v57
    v_lshl_add_u32 v59, v58, 4, v59
    v_add_u32 v18, s84, v59
    v_subrev_u32 v18, 3072, v18
    v_add_u32 v56, 256, v1
    v_mul_u32_u24 v57, 57, v56
    v_lshrrev_b32 v57, 10, v57
    v_mul_u32_u24 v58, 18, v57
    v_sub_u32 v58, v56, v58
    v_mul_u32_u24 v59, 1152, v57
    v_lshl_add_u32 v59, v58, 4, v59
    v_add_u32 v19, s84, v59
    v_mov_b32 v56, 1073741824
    v_cmp_gt_u32 vcc, 32, v1
    s_nop 1
    v_cndmask_b32 v19, v56, v19, vcc
    s_mul_i32 s0, s31, 184320
    s_sub_u32 s1, 184320, s0
    s_mul_i32 s3, s31, -147456
    s_sub_u32 s37, -147456, s3
    s_mul_i32 s88, s33, 288
    s_add_u32 s84, s33, 0
    s_and_b32 s84, s84, 3
    s_lshl_b32 s89, s32, 2
    s_add_u32 s84, s84, s89
    s_lshl_b32 s89, s29, 4
    s_add_u32 s89, s89, s84
    s_mul_i32 s80, s89, 73728
    s_mul_i32 s84, s84, 331776
    s_add_u32 s84, s84, s88
    s_add_u32 s85, s33, 1
    s_and_b32 s85, s85, 3
    s_lshl_b32 s89, s32, 2
    s_add_u32 s85, s85, s89
    s_lshl_b32 s89, s29, 4
    s_add_u32 s89, s89, s85
    s_mul_i32 s81, s89, 73728
    s_mul_i32 s85, s85, 331776
    s_add_u32 s85, s85, s88
    s_add_u32 s86, s33, 2
    s_and_b32 s86, s86, 3
    s_lshl_b32 s89, s32, 2
    s_add_u32 s86, s86, s89
    s_lshl_b32 s89, s29, 4
    s_add_u32 s89, s89, s86
    s_mul_i32 s82, s89, 73728
    s_mul_i32 s86, s86, 331776
    s_add_u32 s86, s86, s88
    s_add_u32 s87, s33, 3
    s_and_b32 s87, s87, 3
    s_lshl_b32 s89, s32, 2
    s_add_u32 s87, s87, s89
    s_lshl_b32 s89, s29, 4
    s_add_u32 s89, s89, s87
    s_mul_i32 s83, s89, 73728
    s_mul_i32 s87, s87, 331776
    s_add_u32 s87, s87, s88
    s_add_u32 s88, s84, s0
    s_add_u32 s88, s88, 0
    s_add_u32 s89, s84, s0
    s_add_u32 s89, s89, 36864
    s_cmp_lt_u32 s28, 2
    s_cselect_b32 s62, s88, s89
    s_add_u32 s88, s84, s0
    s_add_u32 s88, s88, 73728
    s_add_u32 s89, s84, s0
    s_add_u32 s89, s89, 110592
    s_cmp_lt_u32 s28, 2
    s_cselect_b32 s63, s88, s89
    s_add_u32 s88, s84, s3
    s_add_u32 s88, s88, 147456
    s_add_u32 s89, s84, s3
    s_add_u32 s89, s89, 184320
    s_cmp_lt_u32 s28, 2
    s_cselect_b32 s64, s88, s89
    s_add_u32 s88, s84, s3
    s_add_u32 s88, s88, 221184
    s_add_u32 s89, s84, s3
    s_add_u32 s89, s89, 258048
    s_cmp_lt_u32 s28, 2
    s_cselect_b32 s65, s88, s89
    s_add_u32 s88, s84, s3
    s_add_u32 s88, s88, 294912
    s_add_u32 s89, s85, s1
    s_add_u32 s89, s89, 0
    s_cmp_lt_u32 s28, 2
    s_cselect_b32 s66, s88, s89
    s_add_u32 s88, s85, s1
    s_add_u32 s88, s88, 36864
    s_add_u32 s89, s85, s1
    s_add_u32 s89, s89, 73728
    s_cmp_lt_u32 s28, 2
    s_cselect_b32 s67, s88, s89
    s_add_u32 s88, s85, s1
    s_add_u32 s88, s88, 110592
    s_add_u32 s89, s86, s0
    s_add_u32 s89, s89, 0
    s_cmp_lt_u32 s28, 2
    s_cselect_b32 s68, s88, s89
    s_add_u32 s88, s86, s0
    s_add_u32 s88, s88, 36864
    s_add_u32 s89, s86, s0
    s_add_u32 s89, s89, 73728
    s_cmp_lt_u32 s28, 2
    s_cselect_b32 s69, s88, s89
    s_add_u32 s88, s86, s0
    s_add_u32 s88, s88, 110592
    s_add_u32 s89, s87, s1
    s_add_u32 s89, s89, 0
    s_cmp_lt_u32 s28, 2
    s_cselect_b32 s70, s88, s89
    s_add_u32 s88, s87, s1
    s_add_u32 s88, s88, 36864
    s_add_u32 s89, s87, s1
    s_add_u32 s89, s89, 73728
    s_cmp_lt_u32 s28, 2
    s_cselect_b32 s71, s88, s89
    s_add_u32 s88, s87, s1
    s_add_u32 s88, s88, 110592
    s_add_u32 s89, s85, s37
    s_add_u32 s89, s89, 147456
    s_cmp_lt_u32 s28, 2
    s_cselect_b32 s72, s88, s89
    s_add_u32 s88, s85, s37
    s_add_u32 s88, s88, 184320
    s_add_u32 s89, s85, s37
    s_add_u32 s89, s89, 221184
    s_cmp_lt_u32 s28, 2
    s_cselect_b32 s73, s88, s89
    s_add_u32 s88, s86, s3
    s_add_u32 s88, s88, 147456
    s_add_u32 s89, s86, s3
    s_add_u32 s89, s89, 184320
    s_cmp_lt_u32 s28, 2
    s_cselect_b32 s74, s88, s89
    s_add_u32 s88, s86, s3
    s_add_u32 s88, s88, 221184
    s_add_u32 s89, s87, s37
    s_add_u32 s89, s89, 147456
    s_cmp_lt_u32 s28, 2
    s_cselect_b32 s75, s88, s89
    s_add_u32 s88, s87, s37
    s_add_u32 s88, s88, 184320
    s_add_u32 s89, s87, s37
    s_add_u32 s89, s89, 221184
    s_cmp_lt_u32 s28, 2
    s_cselect_b32 s76, s88, s89
    s_add_u32 s88, s85, s37
    s_add_u32 s88, s88, 258048
    s_add_u32 s89, s85, s37
    s_add_u32 s89, s89, 294912
    s_cmp_lt_u32 s28, 2
    s_cselect_b32 s77, s88, s89
    s_add_u32 s88, s86, s3
    s_add_u32 s88, s88, 258048
    s_add_u32 s89, s86, s3
    s_add_u32 s89, s89, 294912
    s_cmp_lt_u32 s28, 2
    s_cselect_b32 s78, s88, s89
    s_add_u32 s88, s87, s37
    s_add_u32 s88, s88, 258048
    s_add_u32 s89, s87, s37
    s_add_u32 s89, s89, 294912
    s_cmp_lt_u32 s28, 2
    s_cselect_b32 s79, s88, s89
    s_or_b32 s88, s2, s28
    v_mov_b32 v53, 1073741824
    v_mov_b32 v54, 42991616
    v_or_b32 v55, s88, v1
    v_cmp_eq_u32 vcc, 0, v55
    s_nop 1
    v_cndmask_b32 v52, v53, v54, vcc
    s_mul_i32 s84, s30, 576
    s_sub_u32 s85, s34, s84
    s_sub_u32 s86, s35, s84
    s_add_u32 s85, s85, 98304
    s_add_u32 s86, s86, 98304
    v_add_u32 v53, s85, v48
    v_add_u32 v54, s86, v48
    v_add_u32 v55, 99328, v48
    s_waitcnt vmcnt(8)
    ds_read_b64 v[130:131], v53 offset:0
    ds_read_b64 v[134:135], v53 offset:32
    ds_read_b64 v[138:139], v53 offset:64
    ds_read_b64 v[142:143], v53 offset:96
    ds_read_b64 v[146:147], v53 offset:128
    ds_read_b64 v[150:151], v53 offset:160
    ds_read_b64 v[154:155], v53 offset:192
    ds_read_b64 v[158:159], v53 offset:224
    ds_read_b64 v[210:211], v54 offset:0
    ds_read_b64 v[214:215], v54 offset:32
    ds_read_b64 v[218:219], v54 offset:64
    ds_read_b64 v[222:223], v54 offset:96
    ds_read_b64 v[226:227], v54 offset:128
    ds_read_b64 v[230:231], v54 offset:160
    ds_read_b64 v[234:235], v54 offset:192
    ds_read_b64 v[238:239], v54 offset:224
    ds_read_b64 v[242:243], v54 offset:256
    ds_read_b64 v[246:247], v54 offset:288
    ds_read_b64 a[224:225], v55 offset:0
    ds_read_b64 a[226:227], v55 offset:32
    ds_read_b64 a[228:229], v55 offset:64
    ds_read_b64 a[230:231], v55 offset:96
    ds_read_b64 a[232:233], v55 offset:128
    ds_read_b64 a[234:235], v55 offset:160
    ds_read_b64 a[236:237], v55 offset:192
    ds_read_b64 a[238:239], v55 offset:224
    ds_read_b64 a[240:241], v55 offset:256
    s_mov_b32 s92, s100
    s_mov_b32 s93, s101
    s_mov_b32 s94, 256
    s_waitcnt lgkmcnt(0)
    v_lshlrev_b32 v128, 16, v130
    v_and_b32 v129, 0xffff0000, v130
    v_lshlrev_b32 v130, 16, v131
    v_and_b32 v131, 0xffff0000, v131
    v_lshlrev_b32 v132, 16, v134
    v_and_b32 v133, 0xffff0000, v134
    v_lshlrev_b32 v134, 16, v135
    v_and_b32 v135, 0xffff0000, v135
    v_lshlrev_b32 v136, 16, v138
    v_and_b32 v137, 0xffff0000, v138
    v_lshlrev_b32 v138, 16, v139
    v_and_b32 v139, 0xffff0000, v139
    v_lshlrev_b32 v140, 16, v142
    v_and_b32 v141, 0xffff0000, v142
    v_lshlrev_b32 v142, 16, v143
    v_and_b32 v143, 0xffff0000, v143
    v_lshlrev_b32 v144, 16, v146
    v_and_b32 v145, 0xffff0000, v146
    v_lshlrev_b32 v146, 16, v147
    v_and_b32 v147, 0xffff0000, v147
    v_lshlrev_b32 v148, 16, v150
    v_and_b32 v149, 0xffff0000, v150
    v_lshlrev_b32 v150, 16, v151
    v_and_b32 v151, 0xffff0000, v151
    v_lshlrev_b32 v152, 16, v154
    v_and_b32 v153, 0xffff0000, v154
    v_lshlrev_b32 v154, 16, v155
    v_and_b32 v155, 0xffff0000, v155
    v_lshlrev_b32 v156, 16, v158
    v_and_b32 v157, 0xffff0000, v158
    v_lshlrev_b32 v158, 16, v159
    v_and_b32 v159, 0xffff0000, v159
    v_lshlrev_b32 v208, 16, v210
    v_and_b32 v209, 0xffff0000, v210
    v_lshlrev_b32 v210, 16, v211
    v_and_b32 v211, 0xffff0000, v211
    v_lshlrev_b32 v212, 16, v214
    v_and_b32 v213, 0xffff0000, v214
    v_lshlrev_b32 v214, 16, v215
    v_and_b32 v215, 0xffff0000, v215
    v_lshlrev_b32 v216, 16, v218
    v_and_b32 v217, 0xffff0000, v218
    v_lshlrev_b32 v218, 16, v219
    v_and_b32 v219, 0xffff0000, v219
    v_lshlrev_b32 v220, 16, v222
    v_and_b32 v221, 0xffff0000, v222
    v_lshlrev_b32 v222, 16, v223
    v_and_b32 v223, 0xffff0000, v223
    v_lshlrev_b32 v224, 16, v226
    v_and_b32 v225, 0xffff0000, v226
    v_lshlrev_b32 v226, 16, v227
    v_and_b32 v227, 0xffff0000, v227
    v_lshlrev_b32 v228, 16, v230
    v_and_b32 v229, 0xffff0000, v230
    v_lshlrev_b32 v230, 16, v231
    v_and_b32 v231, 0xffff0000, v231
    v_lshlrev_b32 v232, 16, v234
    v_and_b32 v233, 0xffff0000, v234
    v_lshlrev_b32 v234, 16, v235
    v_and_b32 v235, 0xffff0000, v235
    v_lshlrev_b32 v236, 16, v238
    v_and_b32 v237, 0xffff0000, v238
    v_lshlrev_b32 v238, 16, v239
    v_and_b32 v239, 0xffff0000, v239
    v_lshlrev_b32 v240, 16, v242
    v_and_b32 v241, 0xffff0000, v242
    v_lshlrev_b32 v242, 16, v243
    v_and_b32 v243, 0xffff0000, v243
    v_lshlrev_b32 v244, 16, v246
    v_and_b32 v245, 0xffff0000, v246
    v_lshlrev_b32 v246, 16, v247
    v_and_b32 v247, 0xffff0000, v247
    s_add_u32 m0, s39, 122880
    s_nop 0
    buffer_load_dwordx4 v11, s[4:7], s54 offen offset:0 lds
    buffer_load_dwordx4 v12, s[4:7], s54 offen offset:1024 lds
    buffer_load_dwordx4 v13, s[4:7], s54 offen offset:2048 lds
    buffer_load_dwordx4 v14, s[4:7], s54 offen offset:3072 lds
    s_add_u32 s36, s34, s45
    s_add_u32 m0, s39, 20480
    s_nop 0
    buffer_load_dwordx4 v2, s[8:11], s36 offen offset:0 lds
    buffer_load_dwordx4 v3, s[8:11], s36 offen offset:1024 lds
    buffer_load_dwordx4 v4, s[8:11], s36 offen offset:2048 lds
    buffer_load_dwordx4 v5, s[8:11], s36 offen offset:3072 lds
    s_waitcnt vmcnt(8)
    s_barrier
    ds_read_b64_tr_b16 a[144:145], v20 offset:0
    ds_read_b64_tr_b16 a[146:147], v20 offset:1024
    ds_read_b64_tr_b16 a[148:149], v21 offset:0
    ds_read_b64_tr_b16 a[150:151], v21 offset:1024
    ds_read_b64_tr_b16 a[152:153], v22 offset:0
    ds_read_b64_tr_b16 a[154:155], v22 offset:1024
    ds_read_b64_tr_b16 a[156:157], v23 offset:0
    ds_read_b64_tr_b16 a[158:159], v23 offset:1024
    ds_read_b64_tr_b16 a[160:161], v24 offset:0
    ds_read_b64_tr_b16 a[162:163], v24 offset:1024
    ds_read_b64_tr_b16 a[164:165], v25 offset:0
    ds_read_b64_tr_b16 a[166:167], v25 offset:1024
    ds_read_b64_tr_b16 a[168:169], v26 offset:0
    ds_read_b64_tr_b16 a[170:171], v26 offset:1024
    ds_read_b64_tr_b16 a[172:173], v27 offset:0
    ds_read_b64_tr_b16 a[174:175], v27 offset:1024
    ds_read_b128 a[0:3], v45 offset:0
    ds_read_b128 a[4:7], v45 offset:2048
    s_waitcnt lgkmcnt(0)
    v_mfma_f32_16x16x32_bf16 v[64:67], a[144:147], a[0:3], v[128:131]
    ds_read_b64_tr_b16 a[184:185], v20 offset:8192
    ds_read_b64_tr_b16 a[186:187], v20 offset:9216
    s_add_u32 m0, s39, 143360
    v_mfma_f32_16x16x32_bf16 v[68:71], a[144:147], a[4:7], v[128:131]
    ds_read_b128 a[8:11], v46 offset:0
    buffer_load_dwordx4 v11, s[4:7], s55 offen offset:0 lds
    v_mfma_f32_16x16x32_bf16 v[72:75], a[148:151], a[0:3], v[132:135]
    ds_read_b64_tr_b16 a[188:189], v21 offset:8192
    v_mfma_f32_16x16x32_bf16 v[76:79], a[148:151], a[4:7], v[132:135]
    ds_read_b64_tr_b16 a[190:191], v21 offset:9216
    buffer_load_dwordx4 v12, s[4:7], s55 offen offset:1024 lds
    v_mfma_f32_16x16x32_bf16 v[80:83], a[152:155], a[0:3], v[136:139]
    ds_read_b128 a[12:15], v46 offset:2048
    v_mfma_f32_16x16x32_bf16 v[84:87], a[152:155], a[4:7], v[136:139]
    ds_read_b64_tr_b16 a[192:193], v22 offset:8192
    v_mfma_f32_16x16x32_bf16 v[88:91], a[156:159], a[0:3], v[140:143]
    ds_read_b64_tr_b16 a[194:195], v22 offset:9216
    buffer_load_dwordx4 v13, s[4:7], s55 offen offset:2048 lds
    v_mfma_f32_16x16x32_bf16 v[92:95], a[156:159], a[4:7], v[140:143]
    ds_read_b64_tr_b16 a[196:197], v23 offset:8192
    v_mfma_f32_16x16x32_bf16 v[96:99], a[160:163], a[0:3], v[144:147]
    ds_read_b64_tr_b16 a[198:199], v23 offset:9216
    ds_read_b64_tr_b16 a[200:201], v24 offset:8192
    v_mfma_f32_16x16x32_bf16 v[100:103], a[160:163], a[4:7], v[144:147]
    ds_read_b64_tr_b16 a[202:203], v24 offset:9216
    buffer_load_dwordx4 v14, s[4:7], s55 offen offset:3072 lds
    s_add_u32 s36, s34, s46
    s_add_u32 m0, s39, 40960
    v_mfma_f32_16x16x32_bf16 v[104:107], a[164:167], a[0:3], v[148:151]
    ds_read_b64_tr_b16 a[204:205], v25 offset:8192
    v_mfma_f32_16x16x32_bf16 v[108:111], a[164:167], a[4:7], v[148:151]
    ds_read_b64_tr_b16 a[206:207], v25 offset:9216
    v_mfma_f32_16x16x32_bf16 v[112:115], a[168:171], a[0:3], v[152:155]
    ds_read_b64_tr_b16 a[208:209], v26 offset:8192
    buffer_load_dwordx4 v2, s[8:11], s36 offen offset:0 lds
    v_mfma_f32_16x16x32_bf16 v[116:119], a[168:171], a[4:7], v[152:155]
    ds_read_b64_tr_b16 a[210:211], v26 offset:9216
    v_mfma_f32_16x16x32_bf16 v[120:123], a[172:175], a[0:3], v[156:159]
    ds_read_b64_tr_b16 a[212:213], v27 offset:8192
    v_mfma_f32_16x16x32_bf16 v[124:127], a[172:175], a[4:7], v[156:159]
    ds_read_b64_tr_b16 a[214:215], v27 offset:9216
    buffer_load_dwordx4 v3, s[8:11], s36 offen offset:1024 lds
    s_waitcnt lgkmcnt(8)
    s_waitcnt vmcnt(6)
    v_mfma_f32_16x16x32_bf16 v[64:67], a[184:187], a[8:11], v[64:67]
    s_barrier
    ds_read_b64_tr_b16 a[144:145], v20 offset:20480
    ds_read_b64_tr_b16 a[146:147], v20 offset:21504
    v_mfma_f32_16x16x32_bf16 v[68:71], a[184:187], a[12:15], v[68:71]
    ds_read_b128 a[16:19], v45 offset:20480
    v_mfma_f32_16x16x32_bf16 v[72:75], a[188:191], a[8:11], v[72:75]
    ds_read_b64_tr_b16 a[148:149], v21 offset:20480
    buffer_load_dwordx4 v4, s[8:11], s36 offen offset:2048 lds
    v_mfma_f32_16x16x32_bf16 v[76:79], a[188:191], a[12:15], v[76:79]
    ds_read_b64_tr_b16 a[150:151], v21 offset:21504
    v_mfma_f32_16x16x32_bf16 v[80:83], a[192:195], a[8:11], v[80:83]
    ds_read_b128 a[20:23], v45 offset:22528
    v_mfma_f32_16x16x32_bf16 v[84:87], a[192:195], a[12:15], v[84:87]
    ds_read_b64_tr_b16 a[152:153], v22 offset:20480
    buffer_load_dwordx4 v5, s[8:11], s36 offen offset:3072 lds
    v_mfma_f32_16x16x32_bf16 v[88:91], a[196:199], a[8:11], v[88:91]
    ds_read_b64_tr_b16 a[154:155], v22 offset:21504
    v_mfma_f32_16x16x32_bf16 v[92:95], a[196:199], a[12:15], v[92:95]
    ds_read_b64_tr_b16 a[156:157], v23 offset:20480
    s_waitcnt lgkmcnt(9)
    v_mfma_f32_16x16x32_bf16 v[96:99], a[200:203], a[8:11], v[96:99]
    ds_read_b64_tr_b16 a[158:159], v23 offset:21504
    ds_read_b64_tr_b16 a[160:161], v24 offset:20480
    buffer_load_dword v51, v52, s[16:19], 0 offen sc1
    s_add_u32 s36, s34, s47
    s_add_u32 m0, s39, 61440
    v_mfma_f32_16x16x32_bf16 v[100:103], a[200:203], a[12:15], v[100:103]
    ds_read_b64_tr_b16 a[162:163], v24 offset:21504
    buffer_load_dwordx4 v2, s[8:11], s36 offen offset:0 lds
    v_mfma_f32_16x16x32_bf16 v[104:107], a[204:207], a[8:11], v[104:107]
    ds_read_b64_tr_b16 a[164:165], v25 offset:20480
    v_mfma_f32_16x16x32_bf16 v[108:111], a[204:207], a[12:15], v[108:111]
    ds_read_b64_tr_b16 a[166:167], v25 offset:21504
    v_mfma_f32_16x16x32_bf16 v[112:115], a[208:211], a[8:11], v[112:115]
    ds_read_b64_tr_b16 a[168:169], v26 offset:20480
    buffer_load_dwordx4 v3, s[8:11], s36 offen offset:1024 lds
    v_mfma_f32_16x16x32_bf16 v[116:119], a[208:211], a[12:15], v[116:119]
    ds_read_b64_tr_b16 a[170:171], v26 offset:21504
    v_mfma_f32_16x16x32_bf16 v[120:123], a[212:215], a[8:11], v[120:123]
    ds_read_b64_tr_b16 a[172:173], v27 offset:20480
    v_mfma_f32_16x16x32_bf16 v[124:127], a[212:215], a[12:15], v[124:127]
    ds_read_b64_tr_b16 a[174:175], v27 offset:21504
    buffer_load_dwordx4 v4, s[8:11], s36 offen offset:2048 lds
    s_waitcnt lgkmcnt(8)
    v_mfma_f32_16x16x32_bf16 v[64:67], a[144:147], a[16:19], v[64:67]
    ds_read_b64_tr_b16 a[184:185], v20 offset:28672
    ds_read_b64_tr_b16 a[186:187], v20 offset:29696
    v_mfma_f32_16x16x32_bf16 v[68:71], a[144:147], a[20:23], v[68:71]
    ds_read_b128 a[24:27], v46 offset:20480
    v_mfma_f32_16x16x32_bf16 v[72:75], a[148:151], a[16:19], v[72:75]
    ds_read_b64_tr_b16 a[188:189], v21 offset:28672
    buffer_load_dwordx4 v5, s[8:11], s36 offen offset:3072 lds
    s_add_u32 s36, s34, s48
    s_add_u32 m0, s39, 81920
    v_mfma_f32_16x16x32_bf16 v[76:79], a[148:151], a[20:23], v[76:79]
    ds_read_b64_tr_b16 a[190:191], v21 offset:29696
    v_mfma_f32_16x16x32_bf16 v[80:83], a[152:155], a[16:19], v[80:83]
    ds_read_b128 a[28:31], v46 offset:22528
    v_mfma_f32_16x16x32_bf16 v[84:87], a[152:155], a[20:23], v[84:87]
    ds_read_b64_tr_b16 a[192:193], v22 offset:28672
    buffer_load_dwordx4 v2, s[8:11], s36 offen offset:0 lds
    v_mfma_f32_16x16x32_bf16 v[88:91], a[156:159], a[16:19], v[88:91]
    ds_read_b64_tr_b16 a[194:195], v22 offset:29696
    v_mfma_f32_16x16x32_bf16 v[92:95], a[156:159], a[20:23], v[92:95]
    ds_read_b64_tr_b16 a[196:197], v23 offset:28672
    s_waitcnt lgkmcnt(9)
    v_mfma_f32_16x16x32_bf16 v[96:99], a[160:163], a[16:19], v[96:99]
    ds_read_b64_tr_b16 a[198:199], v23 offset:29696
    ds_read_b64_tr_b16 a[200:201], v24 offset:28672
    buffer_load_dwordx4 v3, s[8:11], s36 offen offset:1024 lds
    v_mfma_f32_16x16x32_bf16 v[100:103], a[160:163], a[20:23], v[100:103]
    ds_read_b64_tr_b16 a[202:203], v24 offset:29696
    v_mfma_f32_16x16x32_bf16 v[104:107], a[164:167], a[16:19], v[104:107]
    ds_read_b64_tr_b16 a[204:205], v25 offset:28672
    v_mfma_f32_16x16x32_bf16 v[108:111], a[164:167], a[20:23], v[108:111]
    ds_read_b64_tr_b16 a[206:207], v25 offset:29696
    buffer_load_dwordx4 v4, s[8:11], s36 offen offset:2048 lds
    v_mfma_f32_16x16x32_bf16 v[112:115], a[168:171], a[16:19], v[112:115]
    ds_read_b64_tr_b16 a[208:209], v26 offset:28672
    v_mfma_f32_16x16x32_bf16 v[116:119], a[168:171], a[20:23], v[116:119]
    ds_read_b64_tr_b16 a[210:211], v26 offset:29696
    v_mfma_f32_16x16x32_bf16 v[120:123], a[172:175], a[16:19], v[120:123]
    ds_read_b64_tr_b16 a[212:213], v27 offset:28672
    buffer_load_dwordx4 v5, s[8:11], s36 offen offset:3072 lds
    s_add_u32 m0, s39, 102400
    v_mfma_f32_16x16x32_bf16 v[124:127], a[172:175], a[20:23], v[124:127]
    ds_read_b64_tr_b16 a[214:215], v27 offset:29696
    s_waitcnt lgkmcnt(8)
    s_waitcnt vmcnt(9)
    v_mfma_f32_16x16x32_bf16 v[64:67], a[184:187], a[24:27], v[64:67]
    s_barrier
    ds_read_b64_tr_b16 a[144:145], v20 offset:40960
    ds_read_b64_tr_b16 a[146:147], v20 offset:41984
    v_mfma_f32_16x16x32_bf16 v[68:71], a[184:187], a[28:31], v[68:71]
    ds_read_b128 a[32:35], v45 offset:40960
    buffer_load_dwordx4 v11, s[4:7], s56 offen offset:0 lds
    v_mfma_f32_16x16x32_bf16 v[72:75], a[188:191], a[24:27], v[72:75]
    ds_read_b64_tr_b16 a[148:149], v21 offset:40960
    v_mfma_f32_16x16x32_bf16 v[76:79], a[188:191], a[28:31], v[76:79]
    ds_read_b64_tr_b16 a[150:151], v21 offset:41984
    v_mfma_f32_16x16x32_bf16 v[80:83], a[192:195], a[24:27], v[80:83]
    ds_read_b128 a[36:39], v45 offset:43008
    buffer_load_dwordx4 v12, s[4:7], s56 offen offset:1024 lds
    v_mfma_f32_16x16x32_bf16 v[84:87], a[192:195], a[28:31], v[84:87]
    ds_read_b64_tr_b16 a[152:153], v22 offset:40960
    v_mfma_f32_16x16x32_bf16 v[88:91], a[196:199], a[24:27], v[88:91]
    ds_read_b64_tr_b16 a[154:155], v22 offset:41984
    v_mfma_f32_16x16x32_bf16 v[92:95], a[196:199], a[28:31], v[92:95]
    ds_read_b64_tr_b16 a[156:157], v23 offset:40960
    buffer_load_dwordx4 v13, s[4:7], s56 offen offset:2048 lds
    s_waitcnt lgkmcnt(9)
    v_mfma_f32_16x16x32_bf16 v[96:99], a[200:203], a[24:27], v[96:99]
    ds_read_b64_tr_b16 a[158:159], v23 offset:41984
    ds_read_b64_tr_b16 a[160:161], v24 offset:40960
    v_mfma_f32_16x16x32_bf16 v[100:103], a[200:203], a[28:31], v[100:103]
    ds_read_b64_tr_b16 a[162:163], v24 offset:41984
    v_mfma_f32_16x16x32_bf16 v[104:107], a[204:207], a[24:27], v[104:107]
    ds_read_b64_tr_b16 a[164:165], v25 offset:40960
    buffer_load_dwordx4 v14, s[4:7], s56 offen offset:3072 lds
    s_add_u32 m0, s39, 122880
    v_mfma_f32_16x16x32_bf16 v[108:111], a[204:207], a[28:31], v[108:111]
    ds_read_b64_tr_b16 a[166:167], v25 offset:41984
    v_mfma_f32_16x16x32_bf16 v[112:115], a[208:211], a[24:27], v[112:115]
    ds_read_b64_tr_b16 a[168:169], v26 offset:40960
    v_mfma_f32_16x16x32_bf16 v[116:119], a[208:211], a[28:31], v[116:119]
    ds_read_b64_tr_b16 a[170:171], v26 offset:41984
    buffer_load_dwordx4 v11, s[4:7], s57 offen offset:0 lds
    v_mfma_f32_16x16x32_bf16 v[120:123], a[212:215], a[24:27], v[120:123]
    ds_read_b64_tr_b16 a[172:173], v27 offset:40960
    v_mfma_f32_16x16x32_bf16 v[124:127], a[212:215], a[28:31], v[124:127]
    ds_read_b64_tr_b16 a[174:175], v27 offset:41984
    s_waitcnt lgkmcnt(8)
    v_mfma_f32_16x16x32_bf16 v[64:67], a[144:147], a[32:35], v[64:67]
    ds_read_b64_tr_b16 a[184:185], v20 offset:49152
    ds_read_b64_tr_b16 a[186:187], v20 offset:50176
    buffer_load_dwordx4 v12, s[4:7], s57 offen offset:1024 lds
    v_mfma_f32_16x16x32_bf16 v[68:71], a[144:147], a[36:39], v[68:71]
    ds_read_b128 a[40:43], v46 offset:40960
    s_waitcnt vmcnt(14)
    v_mfma_f32_16x16x32_bf16 v[72:75], a[148:151], a[32:35], v[72:75]
    ds_read_b64_tr_b16 a[188:189], v21 offset:49152
    v_add_u32 v51, 1, v51
    v_mfma_f32_16x16x32_bf16 v[76:79], a[148:151], a[36:39], v[76:79]
    ds_read_b64_tr_b16 a[190:191], v21 offset:50176
    buffer_load_dwordx4 v13, s[4:7], s57 offen offset:2048 lds
    v_mfma_f32_16x16x32_bf16 v[80:83], a[152:155], a[32:35], v[80:83]
    ds_read_b128 a[44:47], v46 offset:43008
    v_or_b32 v51, 0x80000000, v51
    v_mfma_f32_16x16x32_bf16 v[84:87], a[152:155], a[36:39], v[84:87]
    ds_read_b64_tr_b16 a[192:193], v22 offset:49152
    buffer_store_dword v51, v52, s[16:19], 0 offen sc1
    v_mfma_f32_16x16x32_bf16 v[88:91], a[156:159], a[32:35], v[88:91]
    ds_read_b64_tr_b16 a[194:195], v22 offset:50176
    buffer_load_dwordx4 v14, s[4:7], s57 offen offset:3072 lds
    s_add_u32 s36, s34, s49
    s_add_u32 m0, s39, 0
    v_mfma_f32_16x16x32_bf16 v[92:95], a[156:159], a[36:39], v[92:95]
    ds_read_b64_tr_b16 a[196:197], v23 offset:49152
    s_waitcnt lgkmcnt(9)
    v_mfma_f32_16x16x32_bf16 v[96:99], a[160:163], a[32:35], v[96:99]
    ds_read_b64_tr_b16 a[198:199], v23 offset:50176
    ds_read_b64_tr_b16 a[200:201], v24 offset:49152
    v_subrev_u32 v52, 42991616, v52
    v_mfma_f32_16x16x32_bf16 v[100:103], a[160:163], a[36:39], v[100:103]
    ds_read_b64_tr_b16 a[202:203], v24 offset:50176
    buffer_load_dwordx4 v2, s[8:11], s36 offen offset:0 lds
    v_mfma_f32_16x16x32_bf16 v[104:107], a[164:167], a[32:35], v[104:107]
    ds_read_b64_tr_b16 a[204:205], v25 offset:49152
    buffer_store_dword v51, v52, s[92:95], 0 offen sc1
    v_mfma_f32_16x16x32_bf16 v[108:111], a[164:167], a[36:39], v[108:111]
    ds_read_b64_tr_b16 a[206:207], v25 offset:50176
    v_mfma_f32_16x16x32_bf16 v[112:115], a[168:171], a[32:35], v[112:115]
    ds_read_b64_tr_b16 a[208:209], v26 offset:49152
    buffer_load_dwordx4 v3, s[8:11], s36 offen offset:1024 lds
    v_mfma_f32_16x16x32_bf16 v[116:119], a[168:171], a[36:39], v[116:119]
    ds_read_b64_tr_b16 a[210:211], v26 offset:50176
    v_mfma_f32_16x16x32_bf16 v[120:123], a[172:175], a[32:35], v[120:123]
    ds_read_b64_tr_b16 a[212:213], v27 offset:49152
    v_mfma_f32_16x16x32_bf16 v[124:127], a[172:175], a[36:39], v[124:127]
    ds_read_b64_tr_b16 a[214:215], v27 offset:50176
    buffer_load_dwordx4 v4, s[8:11], s36 offen offset:2048 lds
    s_waitcnt lgkmcnt(8)
    s_waitcnt vmcnt(9)
    v_mfma_f32_16x16x32_bf16 v[64:67], a[184:187], a[40:43], v[64:67]
    s_barrier
    ds_read_b64_tr_b16 a[144:145], v28 offset:0
    ds_read_b64_tr_b16 a[146:147], v28 offset:1024
    v_mfma_f32_16x16x32_bf16 v[68:71], a[184:187], a[44:47], v[68:71]
    ds_read_b128 a[48:51], v45 offset:0
    v_mfma_f32_16x16x32_bf16 v[72:75], a[188:191], a[40:43], v[72:75]
    ds_read_b64_tr_b16 a[148:149], v29 offset:0
    buffer_load_dwordx4 v5, s[8:11], s36 offen offset:3072 lds
    s_add_u32 m0, s39, 143360
    v_mfma_f32_16x16x32_bf16 v[76:79], a[188:191], a[44:47], v[76:79]
    ds_read_b64_tr_b16 a[150:151], v29 offset:1024
    v_mfma_f32_16x16x32_bf16 v[80:83], a[192:195], a[40:43], v[80:83]
    ds_read_b128 a[52:55], v45 offset:2048
    v_mfma_f32_16x16x32_bf16 v[84:87], a[192:195], a[44:47], v[84:87]
    ds_read_b64_tr_b16 a[152:153], v30 offset:0
    buffer_load_dwordx4 v11, s[4:7], s58 offen offset:0 lds
    v_mfma_f32_16x16x32_bf16 v[88:91], a[196:199], a[40:43], v[88:91]
    ds_read_b64_tr_b16 a[154:155], v30 offset:1024
    v_mfma_f32_16x16x32_bf16 v[92:95], a[196:199], a[44:47], v[92:95]
    ds_read_b64_tr_b16 a[156:157], v31 offset:0
    s_waitcnt lgkmcnt(9)
    v_mfma_f32_16x16x32_bf16 v[96:99], a[200:203], a[40:43], v[96:99]
    ds_read_b64_tr_b16 a[158:159], v31 offset:1024
    ds_read_b64_tr_b16 a[160:161], v32 offset:0
    buffer_load_dwordx4 v12, s[4:7], s58 offen offset:1024 lds
    v_mfma_f32_16x16x32_bf16 v[100:103], a[200:203], a[44:47], v[100:103]
    ds_read_b64_tr_b16 a[162:163], v32 offset:1024
    v_mfma_f32_16x16x32_bf16 v[104:107], a[204:207], a[40:43], v[104:107]
    ds_read_b64_tr_b16 a[164:165], v33 offset:0
    v_mfma_f32_16x16x32_bf16 v[108:111], a[204:207], a[44:47], v[108:111]
    ds_read_b64_tr_b16 a[166:167], v33 offset:1024
    buffer_load_dwordx4 v13, s[4:7], s58 offen offset:2048 lds
    v_mfma_f32_16x16x32_bf16 v[112:115], a[208:211], a[40:43], v[112:115]
    ds_read_b64_tr_b16 a[168:169], v34 offset:0
    v_mfma_f32_16x16x32_bf16 v[116:119], a[208:211], a[44:47], v[116:119]
    ds_read_b64_tr_b16 a[170:171], v34 offset:1024
    v_mfma_f32_16x16x32_bf16 v[120:123], a[212:215], a[40:43], v[120:123]
    ds_read_b64_tr_b16 a[172:173], v35 offset:0
    buffer_load_dwordx4 v14, s[4:7], s58 offen offset:3072 lds
    s_add_u32 s36, s34, s50
    s_add_u32 m0, s39, 20480
    v_mfma_f32_16x16x32_bf16 v[124:127], a[212:215], a[44:47], v[124:127]
    ds_read_b64_tr_b16 a[174:175], v35 offset:1024
    s_waitcnt lgkmcnt(8)
    v_mfma_f32_16x16x32_bf16 v[64:67], a[144:147], a[48:51], v[64:67]
    ds_read_b64_tr_b16 a[184:185], v28 offset:8192
    ds_read_b64_tr_b16 a[186:187], v28 offset:9216
    v_mfma_f32_16x16x32_bf16 v[68:71], a[144:147], a[52:55], v[68:71]
    ds_read_b128 a[56:59], v46 offset:0
    buffer_load_dwordx4 v2, s[8:11], s36 offen offset:0 lds
    v_mfma_f32_16x16x32_bf16 v[72:75], a[148:151], a[48:51], v[72:75]
    ds_read_b64_tr_b16 a[188:189], v29 offset:8192
    v_mfma_f32_16x16x32_bf16 v[76:79], a[148:151], a[52:55], v[76:79]
    ds_read_b64_tr_b16 a[190:191], v29 offset:9216
    v_mfma_f32_16x16x32_bf16 v[80:83], a[152:155], a[48:51], v[80:83]
    ds_read_b128 a[60:63], v46 offset:2048
    buffer_load_dwordx4 v3, s[8:11], s36 offen offset:1024 lds
    v_mfma_f32_16x16x32_bf16 v[84:87], a[152:155], a[52:55], v[84:87]
    ds_read_b64_tr_b16 a[192:193], v30 offset:8192
    v_mfma_f32_16x16x32_bf16 v[88:91], a[156:159], a[48:51], v[88:91]
    ds_read_b64_tr_b16 a[194:195], v30 offset:9216
    v_mfma_f32_16x16x32_bf16 v[92:95], a[156:159], a[52:55], v[92:95]
    ds_read_b64_tr_b16 a[196:197], v31 offset:8192
    buffer_load_dwordx4 v4, s[8:11], s36 offen offset:2048 lds
    s_waitcnt lgkmcnt(9)
    v_mfma_f32_16x16x32_bf16 v[96:99], a[160:163], a[48:51], v[96:99]
    ds_read_b64_tr_b16 a[198:199], v31 offset:9216
    ds_read_b64_tr_b16 a[200:201], v32 offset:8192
    v_mfma_f32_16x16x32_bf16 v[100:103], a[160:163], a[52:55], v[100:103]
    ds_read_b64_tr_b16 a[202:203], v32 offset:9216
    v_mfma_f32_16x16x32_bf16 v[104:107], a[164:167], a[48:51], v[104:107]
    ds_read_b64_tr_b16 a[204:205], v33 offset:8192
    buffer_load_dwordx4 v5, s[8:11], s36 offen offset:3072 lds
    v_mfma_f32_16x16x32_bf16 v[108:111], a[164:167], a[52:55], v[108:111]
    ds_read_b64_tr_b16 a[206:207], v33 offset:9216
    v_mfma_f32_16x16x32_bf16 v[112:115], a[168:171], a[48:51], v[112:115]
    ds_read_b64_tr_b16 a[208:209], v34 offset:8192
    v_mfma_f32_16x16x32_bf16 v[116:119], a[168:171], a[52:55], v[116:119]
    ds_read_b64_tr_b16 a[210:211], v34 offset:9216
    v_mfma_f32_16x16x32_bf16 v[120:123], a[172:175], a[48:51], v[120:123]
    ds_read_b64_tr_b16 a[212:213], v35 offset:8192
    v_mfma_f32_16x16x32_bf16 v[124:127], a[172:175], a[52:55], v[124:127]
    ds_read_b64_tr_b16 a[214:215], v35 offset:9216
    s_waitcnt lgkmcnt(8)
    s_waitcnt vmcnt(13)
    v_mfma_f32_16x16x32_bf16 v[64:67], a[184:187], a[56:59], v[64:67]
    s_barrier
    ds_read_b64_tr_b16 a[144:145], v28 offset:20480
    ds_read_b64_tr_b16 a[146:147], v28 offset:21504
    s_add_u32 m0, s39, 102400
    v_mfma_f32_16x16x32_bf16 v[68:71], a[184:187], a[60:63], v[68:71]
    ds_read_b128 a[64:67], v45 offset:20480
    buffer_load_dwordx4 v11, s[4:7], s59 offen offset:0 lds
    v_mfma_f32_16x16x32_bf16 v[72:75], a[188:191], a[56:59], v[72:75]
    ds_read_b64_tr_b16 a[148:149], v29 offset:20480
    v_mfma_f32_16x16x32_bf16 v[76:79], a[188:191], a[60:63], v[76:79]
    ds_read_b64_tr_b16 a[150:151], v29 offset:21504
    buffer_load_dwordx4 v12, s[4:7], s59 offen offset:1024 lds
    v_mfma_f32_16x16x32_bf16 v[80:83], a[192:195], a[56:59], v[80:83]
    ds_read_b128 a[68:71], v45 offset:22528
    v_mfma_f32_16x16x32_bf16 v[84:87], a[192:195], a[60:63], v[84:87]
    ds_read_b64_tr_b16 a[152:153], v30 offset:20480
    v_mfma_f32_16x16x32_bf16 v[88:91], a[196:199], a[56:59], v[88:91]
    ds_read_b64_tr_b16 a[154:155], v30 offset:21504
    buffer_load_dwordx4 v13, s[4:7], s59 offen offset:2048 lds
    v_mfma_f32_16x16x32_bf16 v[92:95], a[196:199], a[60:63], v[92:95]
    ds_read_b64_tr_b16 a[156:157], v31 offset:20480
    s_waitcnt lgkmcnt(9)
    v_mfma_f32_16x16x32_bf16 v[96:99], a[200:203], a[56:59], v[96:99]
    ds_read_b64_tr_b16 a[158:159], v31 offset:21504
    ds_read_b64_tr_b16 a[160:161], v32 offset:20480
    v_mfma_f32_16x16x32_bf16 v[100:103], a[200:203], a[60:63], v[100:103]
    ds_read_b64_tr_b16 a[162:163], v32 offset:21504
    buffer_load_dwordx4 v14, s[4:7], s59 offen offset:3072 lds
    s_add_u32 s36, s34, s51
    s_add_u32 m0, s39, 40960
    v_mfma_f32_16x16x32_bf16 v[104:107], a[204:207], a[56:59], v[104:107]
    ds_read_b64_tr_b16 a[164:165], v33 offset:20480
    v_mfma_f32_16x16x32_bf16 v[108:111], a[204:207], a[60:63], v[108:111]
    ds_read_b64_tr_b16 a[166:167], v33 offset:21504
    v_mfma_f32_16x16x32_bf16 v[112:115], a[208:211], a[56:59], v[112:115]
    ds_read_b64_tr_b16 a[168:169], v34 offset:20480
    buffer_load_dwordx4 v2, s[8:11], s36 offen offset:0 lds
    v_mfma_f32_16x16x32_bf16 v[116:119], a[208:211], a[60:63], v[116:119]
    ds_read_b64_tr_b16 a[170:171], v34 offset:21504
    v_mfma_f32_16x16x32_bf16 v[120:123], a[212:215], a[56:59], v[120:123]
    ds_read_b64_tr_b16 a[172:173], v35 offset:20480
    v_mfma_f32_16x16x32_bf16 v[124:127], a[212:215], a[60:63], v[124:127]
    ds_read_b64_tr_b16 a[174:175], v35 offset:21504
    buffer_load_dwordx4 v3, s[8:11], s36 offen offset:1024 lds
    s_waitcnt lgkmcnt(8)
    v_mfma_f32_16x16x32_bf16 v[64:67], a[144:147], a[64:67], v[64:67]
    ds_read_b64_tr_b16 a[184:185], v28 offset:28672
    ds_read_b64_tr_b16 a[186:187], v28 offset:29696
    v_mfma_f32_16x16x32_bf16 v[68:71], a[144:147], a[68:71], v[68:71]
    ds_read_b128 a[72:75], v46 offset:20480
    v_mfma_f32_16x16x32_bf16 v[72:75], a[148:151], a[64:67], v[72:75]
    ds_read_b64_tr_b16 a[188:189], v29 offset:28672
    buffer_load_dwordx4 v4, s[8:11], s36 offen offset:2048 lds
    v_mfma_f32_16x16x32_bf16 v[76:79], a[148:151], a[68:71], v[76:79]
    ds_read_b64_tr_b16 a[190:191], v29 offset:29696
    v_mfma_f32_16x16x32_bf16 v[80:83], a[152:155], a[64:67], v[80:83]
    ds_read_b128 a[76:79], v46 offset:22528
    v_mfma_f32_16x16x32_bf16 v[84:87], a[152:155], a[68:71], v[84:87]
    ds_read_b64_tr_b16 a[192:193], v30 offset:28672
    buffer_load_dwordx4 v5, s[8:11], s36 offen offset:3072 lds
    v_mfma_f32_16x16x32_bf16 v[88:91], a[156:159], a[64:67], v[88:91]
    ds_read_b64_tr_b16 a[194:195], v30 offset:29696
    v_mfma_f32_16x16x32_bf16 v[92:95], a[156:159], a[68:71], v[92:95]
    ds_read_b64_tr_b16 a[196:197], v31 offset:28672
    s_waitcnt lgkmcnt(9)
    v_mfma_f32_16x16x32_bf16 v[96:99], a[160:163], a[64:67], v[96:99]
    ds_read_b64_tr_b16 a[198:199], v31 offset:29696
    ds_read_b64_tr_b16 a[200:201], v32 offset:28672
    v_mfma_f32_16x16x32_bf16 v[100:103], a[160:163], a[68:71], v[100:103]
    ds_read_b64_tr_b16 a[202:203], v32 offset:29696
    v_mfma_f32_16x16x32_bf16 v[104:107], a[164:167], a[64:67], v[104:107]
    ds_read_b64_tr_b16 a[204:205], v33 offset:28672
    v_mfma_f32_16x16x32_bf16 v[108:111], a[164:167], a[68:71], v[108:111]
    ds_read_b64_tr_b16 a[206:207], v33 offset:29696
    v_mfma_f32_16x16x32_bf16 v[112:115], a[168:171], a[64:67], v[112:115]
    ds_read_b64_tr_b16 a[208:209], v34 offset:28672
    v_mfma_f32_16x16x32_bf16 v[116:119], a[168:171], a[68:71], v[116:119]
    ds_read_b64_tr_b16 a[210:211], v34 offset:29696
    v_mfma_f32_16x16x32_bf16 v[120:123], a[172:175], a[64:67], v[120:123]
    ds_read_b64_tr_b16 a[212:213], v35 offset:28672
    v_mfma_f32_16x16x32_bf16 v[124:127], a[172:175], a[68:71], v[124:127]
    ds_read_b64_tr_b16 a[214:215], v35 offset:29696
    s_waitcnt lgkmcnt(8)
    s_waitcnt vmcnt(12)
    v_mfma_f32_16x16x32_bf16 v[64:67], a[184:187], a[72:75], v[64:67]
    s_barrier
    ds_read_b64_tr_b16 a[144:145], v20 offset:0
    ds_read_b64_tr_b16 a[146:147], v20 offset:1024
    s_add_u32 m0, s39, 122880
    v_mfma_f32_16x16x32_bf16 v[68:71], a[184:187], a[76:79], v[68:71]
    ds_read_b128 a[80:83], v45 offset:40960
    buffer_load_dwordx4 v11, s[4:7], s60 offen offset:0 lds
    v_mfma_f32_16x16x32_bf16 v[72:75], a[188:191], a[72:75], v[72:75]
    ds_read_b64_tr_b16 a[148:149], v21 offset:0
    v_mfma_f32_16x16x32_bf16 v[76:79], a[188:191], a[76:79], v[76:79]
    ds_read_b64_tr_b16 a[150:151], v21 offset:1024
    buffer_load_dwordx4 v12, s[4:7], s60 offen offset:1024 lds
    v_mfma_f32_16x16x32_bf16 v[80:83], a[192:195], a[72:75], v[80:83]
    ds_read_b128 a[84:87], v45 offset:43008
    v_mfma_f32_16x16x32_bf16 v[84:87], a[192:195], a[76:79], v[84:87]
    ds_read_b64_tr_b16 a[152:153], v22 offset:0
    v_mfma_f32_16x16x32_bf16 v[88:91], a[196:199], a[72:75], v[88:91]
    ds_read_b64_tr_b16 a[154:155], v22 offset:1024
    buffer_load_dwordx4 v13, s[4:7], s60 offen offset:2048 lds
    v_mfma_f32_16x16x32_bf16 v[92:95], a[196:199], a[76:79], v[92:95]
    ds_read_b64_tr_b16 a[156:157], v23 offset:0
    s_waitcnt lgkmcnt(9)
    v_mfma_f32_16x16x32_bf16 v[96:99], a[200:203], a[72:75], v[96:99]
    ds_read_b64_tr_b16 a[158:159], v23 offset:1024
    ds_read_b64_tr_b16 a[160:161], v24 offset:0
    v_mfma_f32_16x16x32_bf16 v[100:103], a[200:203], a[76:79], v[100:103]
    ds_read_b64_tr_b16 a[162:163], v24 offset:1024
    buffer_load_dwordx4 v14, s[4:7], s60 offen offset:3072 lds
    s_add_u32 s36, s34, s52
    s_add_u32 m0, s39, 61440
    v_mfma_f32_16x16x32_bf16 v[104:107], a[204:207], a[72:75], v[104:107]
    ds_read_b64_tr_b16 a[164:165], v25 offset:0
    v_mfma_f32_16x16x32_bf16 v[108:111], a[204:207], a[76:79], v[108:111]
    ds_read_b64_tr_b16 a[166:167], v25 offset:1024
    v_mfma_f32_16x16x32_bf16 v[112:115], a[208:211], a[72:75], v[112:115]
    ds_read_b64_tr_b16 a[168:169], v26 offset:0
    buffer_load_dwordx4 v2, s[8:11], s36 offen offset:0 lds
    v_mfma_f32_16x16x32_bf16 v[116:119], a[208:211], a[76:79], v[116:119]
    ds_read_b64_tr_b16 a[170:171], v26 offset:1024
    v_mfma_f32_16x16x32_bf16 v[120:123], a[212:215], a[72:75], v[120:123]
    ds_read_b64_tr_b16 a[172:173], v27 offset:0
    v_mfma_f32_16x16x32_bf16 v[124:127], a[212:215], a[76:79], v[124:127]
    ds_read_b64_tr_b16 a[174:175], v27 offset:1024
    buffer_load_dwordx4 v3, s[8:11], s36 offen offset:1024 lds
    s_waitcnt lgkmcnt(8)
    v_mfma_f32_16x16x32_bf16 v[64:67], a[144:147], a[80:83], v[64:67]
    ds_read_b64_tr_b16 a[184:185], v20 offset:8192
    ds_read_b64_tr_b16 a[186:187], v20 offset:9216
    v_mfma_f32_16x16x32_bf16 v[68:71], a[144:147], a[84:87], v[68:71]
    ds_read_b128 a[88:91], v46 offset:40960
    v_mfma_f32_16x16x32_bf16 v[72:75], a[148:151], a[80:83], v[72:75]
    ds_read_b64_tr_b16 a[188:189], v21 offset:8192
    buffer_load_dwordx4 v4, s[8:11], s36 offen offset:2048 lds
    v_mfma_f32_16x16x32_bf16 v[76:79], a[148:151], a[84:87], v[76:79]
    ds_read_b64_tr_b16 a[190:191], v21 offset:9216
    v_mfma_f32_16x16x32_bf16 v[80:83], a[152:155], a[80:83], v[80:83]
    ds_read_b128 a[92:95], v46 offset:43008
    v_mfma_f32_16x16x32_bf16 v[84:87], a[152:155], a[84:87], v[84:87]
    ds_read_b64_tr_b16 a[192:193], v22 offset:8192
    buffer_load_dwordx4 v5, s[8:11], s36 offen offset:3072 lds
    v_mfma_f32_16x16x32_bf16 v[88:91], a[156:159], a[80:83], v[88:91]
    ds_read_b64_tr_b16 a[194:195], v22 offset:9216
    v_mfma_f32_16x16x32_bf16 v[92:95], a[156:159], a[84:87], v[92:95]
    ds_read_b64_tr_b16 a[196:197], v23 offset:8192
    s_waitcnt lgkmcnt(9)
    v_mfma_f32_16x16x32_bf16 v[96:99], a[160:163], a[80:83], v[96:99]
    ds_read_b64_tr_b16 a[198:199], v23 offset:9216
    ds_read_b64_tr_b16 a[200:201], v24 offset:8192
    v_mfma_f32_16x16x32_bf16 v[100:103], a[160:163], a[84:87], v[100:103]
    ds_read_b64_tr_b16 a[202:203], v24 offset:9216
    v_mfma_f32_16x16x32_bf16 v[104:107], a[164:167], a[80:83], v[104:107]
    ds_read_b64_tr_b16 a[204:205], v25 offset:8192
    v_mfma_f32_16x16x32_bf16 v[108:111], a[164:167], a[84:87], v[108:111]
    ds_read_b64_tr_b16 a[206:207], v25 offset:9216
    v_mfma_f32_16x16x32_bf16 v[112:115], a[168:171], a[80:83], v[112:115]
    ds_read_b64_tr_b16 a[208:209], v26 offset:8192
    v_mfma_f32_16x16x32_bf16 v[116:119], a[168:171], a[84:87], v[116:119]
    ds_read_b64_tr_b16 a[210:211], v26 offset:9216
    v_mfma_f32_16x16x32_bf16 v[120:123], a[172:175], a[80:83], v[120:123]
    ds_read_b64_tr_b16 a[212:213], v27 offset:8192
    v_mfma_f32_16x16x32_bf16 v[124:127], a[172:175], a[84:87], v[124:127]
    ds_read_b64_tr_b16 a[214:215], v27 offset:9216
    s_waitcnt lgkmcnt(8)
    s_waitcnt vmcnt(12)
    v_mfma_f32_16x16x32_bf16 v[64:67], a[184:187], a[88:91], v[64:67]
    s_barrier
    ds_read_b64_tr_b16 a[144:145], v20 offset:20480
    ds_read_b64_tr_b16 a[146:147], v20 offset:21504
    s_add_u32 m0, s39, 143360
    v_mfma_f32_16x16x32_bf16 v[68:71], a[184:187], a[92:95], v[68:71]
    ds_read_b128 a[96:99], v45 offset:0
    buffer_load_dwordx4 v11, s[4:7], s61 offen offset:0 lds
    v_mfma_f32_16x16x32_bf16 v[72:75], a[188:191], a[88:91], v[72:75]
    ds_read_b64_tr_b16 a[148:149], v21 offset:20480
    v_mfma_f32_16x16x32_bf16 v[76:79], a[188:191], a[92:95], v[76:79]
    ds_read_b64_tr_b16 a[150:151], v21 offset:21504
    buffer_load_dwordx4 v12, s[4:7], s61 offen offset:1024 lds
    v_mfma_f32_16x16x32_bf16 v[80:83], a[192:195], a[88:91], v[80:83]
    ds_read_b128 a[100:103], v45 offset:2048
    v_mfma_f32_16x16x32_bf16 v[84:87], a[192:195], a[92:95], v[84:87]
    ds_read_b64_tr_b16 a[152:153], v22 offset:20480
    v_mfma_f32_16x16x32_bf16 v[88:91], a[196:199], a[88:91], v[88:91]
    ds_read_b64_tr_b16 a[154:155], v22 offset:21504
    buffer_load_dwordx4 v13, s[4:7], s61 offen offset:2048 lds
    v_mfma_f32_16x16x32_bf16 v[92:95], a[196:199], a[92:95], v[92:95]
    ds_read_b64_tr_b16 a[156:157], v23 offset:20480
    s_waitcnt lgkmcnt(9)
    v_mfma_f32_16x16x32_bf16 v[96:99], a[200:203], a[88:91], v[96:99]
    ds_read_b64_tr_b16 a[158:159], v23 offset:21504
    ds_read_b64_tr_b16 a[160:161], v24 offset:20480
    v_mfma_f32_16x16x32_bf16 v[100:103], a[200:203], a[92:95], v[100:103]
    ds_read_b64_tr_b16 a[162:163], v24 offset:21504
    buffer_load_dwordx4 v14, s[4:7], s61 offen offset:3072 lds
    s_add_u32 s36, s35, s44
    s_add_u32 m0, s38, 81920
    v_mfma_f32_16x16x32_bf16 v[104:107], a[204:207], a[88:91], v[104:107]
    ds_read_b64_tr_b16 a[164:165], v25 offset:20480
    v_mfma_f32_16x16x32_bf16 v[108:111], a[204:207], a[92:95], v[108:111]
    ds_read_b64_tr_b16 a[166:167], v25 offset:21504
    v_mfma_f32_16x16x32_bf16 v[112:115], a[208:211], a[88:91], v[112:115]
    ds_read_b64_tr_b16 a[168:169], v26 offset:20480
    buffer_load_dwordx4 v6, s[8:11], s36 offen offset:0 lds
    v_mfma_f32_16x16x32_bf16 v[116:119], a[208:211], a[92:95], v[116:119]
    ds_read_b64_tr_b16 a[170:171], v26 offset:21504
    v_mfma_f32_16x16x32_bf16 v[120:123], a[212:215], a[88:91], v[120:123]
    ds_read_b64_tr_b16 a[172:173], v27 offset:20480
    v_mfma_f32_16x16x32_bf16 v[124:127], a[212:215], a[92:95], v[124:127]
    ds_read_b64_tr_b16 a[174:175], v27 offset:21504
    s_waitcnt lgkmcnt(8)
    v_mfma_f32_16x16x32_bf16 v[64:67], a[144:147], a[96:99], v[64:67]
    ds_read_b64_tr_b16 a[184:185], v20 offset:28672
    ds_read_b64_tr_b16 a[186:187], v20 offset:29696
    v_mfma_f32_16x16x32_bf16 v[68:71], a[144:147], a[100:103], v[68:71]
    ds_read_b128 a[104:107], v46 offset:0
    buffer_load_dwordx4 v7, s[8:11], s36 offen offset:1024 lds
    v_mfma_f32_16x16x32_bf16 v[72:75], a[148:151], a[96:99], v[72:75]
    ds_read_b64_tr_b16 a[188:189], v21 offset:28672
    v_mov_b32 v52, 0
    v_mfma_f32_16x16x32_bf16 v[76:79], a[148:151], a[100:103], v[76:79]
    ds_read_b64_tr_b16 a[190:191], v21 offset:29696
    buffer_load_dword v51, v52, s[92:95], 0 offen sc1
    v_mfma_f32_16x16x32_bf16 v[80:83], a[152:155], a[96:99], v[80:83]
    ds_read_b128 a[108:111], v46 offset:2048
    v_mfma_f32_16x16x32_bf16 v[84:87], a[152:155], a[100:103], v[84:87]
    ds_read_b64_tr_b16 a[192:193], v22 offset:28672
    buffer_load_dwordx4 v8, s[8:11], s36 offen offset:2048 lds
    v_mfma_f32_16x16x32_bf16 v[88:91], a[156:159], a[96:99], v[88:91]
    ds_read_b64_tr_b16 a[194:195], v22 offset:29696
    v_mfma_f32_16x16x32_bf16 v[92:95], a[156:159], a[100:103], v[92:95]
    ds_read_b64_tr_b16 a[196:197], v23 offset:28672
    s_waitcnt lgkmcnt(9)
    v_mfma_f32_16x16x32_bf16 v[96:99], a[160:163], a[96:99], v[96:99]
    ds_read_b64_tr_b16 a[198:199], v23 offset:29696
    ds_read_b64_tr_b16 a[200:201], v24 offset:28672
    v_mfma_f32_16x16x32_bf16 v[100:103], a[160:163], a[100:103], v[100:103]
    ds_read_b64_tr_b16 a[202:203], v24 offset:29696
    v_mfma_f32_16x16x32_bf16 v[104:107], a[164:167], a[96:99], v[104:107]
    ds_read_b64_tr_b16 a[204:205], v25 offset:28672
    buffer_load_dwordx4 v9, s[8:11], s36 offen offset:3072 lds
    s_add_u32 m0, s38, 86016
    v_mfma_f32_16x16x32_bf16 v[108:111], a[164:167], a[100:103], v[108:111]
    ds_read_b64_tr_b16 a[206:207], v25 offset:29696
    v_mfma_f32_16x16x32_bf16 v[112:115], a[168:171], a[96:99], v[112:115]
    ds_read_b64_tr_b16 a[208:209], v26 offset:28672
    v_mfma_f32_16x16x32_bf16 v[116:119], a[168:171], a[100:103], v[116:119]
    ds_read_b64_tr_b16 a[210:211], v26 offset:29696
    v_mfma_f32_16x16x32_bf16 v[120:123], a[172:175], a[96:99], v[120:123]
    ds_read_b64_tr_b16 a[212:213], v27 offset:28672
    buffer_load_dwordx4 v10, s[8:11], s36 offen lds
    v_mfma_f32_16x16x32_bf16 v[124:127], a[172:175], a[100:103], v[124:127]
    ds_read_b64_tr_b16 a[214:215], v27 offset:29696
    s_waitcnt lgkmcnt(8)
    s_waitcnt vmcnt(14)
    v_mfma_f32_16x16x32_bf16 v[64:67], a[184:187], a[104:107], v[64:67]
    s_barrier
    ds_read_b64_tr_b16 a[144:145], v20 offset:40960
    ds_read_b64_tr_b16 a[146:147], v20 offset:41984
    s_add_u32 s36, s35, s45
    s_add_u32 m0, s38, 0
    v_mfma_f32_16x16x32_bf16 v[68:71], a[184:187], a[108:111], v[68:71]
    ds_read_b128 a[112:115], v45 offset:20480
    v_mfma_f32_16x16x32_bf16 v[72:75], a[188:191], a[104:107], v[72:75]
    ds_read_b64_tr_b16 a[148:149], v21 offset:40960
    v_mfma_f32_16x16x32_bf16 v[76:79], a[188:191], a[108:111], v[76:79]
    ds_read_b64_tr_b16 a[150:151], v21 offset:41984
    buffer_load_dwordx4 v6, s[8:11], s36 offen offset:0 lds
    v_mfma_f32_16x16x32_bf16 v[80:83], a[192:195], a[104:107], v[80:83]
    ds_read_b128 a[116:119], v45 offset:22528
    v_mfma_f32_16x16x32_bf16 v[84:87], a[192:195], a[108:111], v[84:87]
    ds_read_b64_tr_b16 a[152:153], v22 offset:40960
    v_mfma_f32_16x16x32_bf16 v[88:91], a[196:199], a[104:107], v[88:91]
    ds_read_b64_tr_b16 a[154:155], v22 offset:41984
    v_mfma_f32_16x16x32_bf16 v[92:95], a[196:199], a[108:111], v[92:95]
    ds_read_b64_tr_b16 a[156:157], v23 offset:40960
    buffer_load_dwordx4 v7, s[8:11], s36 offen offset:1024 lds
    s_waitcnt lgkmcnt(9)
    v_mfma_f32_16x16x32_bf16 v[96:99], a[200:203], a[104:107], v[96:99]
    ds_read_b64_tr_b16 a[158:159], v23 offset:41984
    ds_read_b64_tr_b16 a[160:161], v24 offset:40960
    v_mfma_f32_16x16x32_bf16 v[100:103], a[200:203], a[108:111], v[100:103]
    ds_read_b64_tr_b16 a[162:163], v24 offset:41984
    v_mfma_f32_16x16x32_bf16 v[104:107], a[204:207], a[104:107], v[104:107]
    ds_read_b64_tr_b16 a[164:165], v25 offset:40960
    v_mfma_f32_16x16x32_bf16 v[108:111], a[204:207], a[108:111], v[108:111]
    ds_read_b64_tr_b16 a[166:167], v25 offset:41984
    v_mfma_f32_16x16x32_bf16 v[112:115], a[208:211], a[104:107], v[112:115]
    ds_read_b64_tr_b16 a[168:169], v26 offset:40960
    buffer_load_dwordx4 v8, s[8:11], s36 offen offset:2048 lds
    v_mfma_f32_16x16x32_bf16 v[116:119], a[208:211], a[108:111], v[116:119]
    ds_read_b64_tr_b16 a[170:171], v26 offset:41984
    v_mfma_f32_16x16x32_bf16 v[120:123], a[212:215], a[104:107], v[120:123]
    ds_read_b64_tr_b16 a[172:173], v27 offset:40960
    v_mfma_f32_16x16x32_bf16 v[124:127], a[212:215], a[108:111], v[124:127]
    ds_read_b64_tr_b16 a[174:175], v27 offset:41984
    s_waitcnt lgkmcnt(8)
    v_mfma_f32_16x16x32_bf16 v[64:67], a[144:147], a[112:115], v[64:67]
    ds_read_b64_tr_b16 a[184:185], v20 offset:49152
    ds_read_b64_tr_b16 a[186:187], v20 offset:50176
    buffer_load_dwordx4 v9, s[8:11], s36 offen offset:3072 lds
    s_add_u32 m0, s38, 4096
    v_mfma_f32_16x16x32_bf16 v[68:71], a[144:147], a[116:119], v[68:71]
    ds_read_b128 a[120:123], v46 offset:20480
    v_mfma_f32_16x16x32_bf16 v[72:75], a[148:151], a[112:115], v[72:75]
    ds_read_b64_tr_b16 a[188:189], v21 offset:49152
    v_mfma_f32_16x16x32_bf16 v[76:79], a[148:151], a[116:119], v[76:79]
    ds_read_b64_tr_b16 a[190:191], v21 offset:50176
    v_mfma_f32_16x16x32_bf16 v[80:83], a[152:155], a[112:115], v[80:83]
    ds_read_b128 a[124:127], v46 offset:22528
    v_mfma_f32_16x16x32_bf16 v[84:87], a[152:155], a[116:119], v[84:87]
    ds_read_b64_tr_b16 a[192:193], v22 offset:49152
    buffer_load_dwordx4 v10, s[8:11], s36 offen lds
    s_add_u32 s36, s35, s46
    s_add_u32 m0, s38, 102400
    v_mfma_f32_16x16x32_bf16 v[88:91], a[156:159], a[112:115], v[88:91]
    ds_read_b64_tr_b16 a[194:195], v22 offset:50176
    v_mfma_f32_16x16x32_bf16 v[92:95], a[156:159], a[116:119], v[92:95]
    ds_read_b64_tr_b16 a[196:197], v23 offset:49152
    s_waitcnt lgkmcnt(9)
    v_mfma_f32_16x16x32_bf16 v[96:99], a[160:163], a[112:115], v[96:99]
    ds_read_b64_tr_b16 a[198:199], v23 offset:50176
    ds_read_b64_tr_b16 a[200:201], v24 offset:49152
    v_mfma_f32_16x16x32_bf16 v[100:103], a[160:163], a[116:119], v[100:103]
    ds_read_b64_tr_b16 a[202:203], v24 offset:50176
    buffer_load_dwordx4 v6, s[8:11], s36 offen offset:0 lds
    v_mfma_f32_16x16x32_bf16 v[104:107], a[164:167], a[112:115], v[104:107]
    ds_read_b64_tr_b16 a[204:205], v25 offset:49152
    v_mfma_f32_16x16x32_bf16 v[108:111], a[164:167], a[116:119], v[108:111]
    ds_read_b64_tr_b16 a[206:207], v25 offset:50176
    v_mfma_f32_16x16x32_bf16 v[112:115], a[168:171], a[112:115], v[112:115]
    ds_read_b64_tr_b16 a[208:209], v26 offset:49152
    v_mfma_f32_16x16x32_bf16 v[116:119], a[168:171], a[116:119], v[116:119]
    ds_read_b64_tr_b16 a[210:211], v26 offset:50176
    v_mfma_f32_16x16x32_bf16 v[120:123], a[172:175], a[112:115], v[120:123]
    ds_read_b64_tr_b16 a[212:213], v27 offset:49152
    buffer_load_dwordx4 v7, s[8:11], s36 offen offset:1024 lds
    v_mfma_f32_16x16x32_bf16 v[124:127], a[172:175], a[116:119], v[124:127]
    ds_read_b64_tr_b16 a[214:215], v27 offset:50176
    s_waitcnt lgkmcnt(8)
    s_waitcnt vmcnt(13)
    v_mfma_f32_16x16x32_bf16 v[64:67], a[184:187], a[120:123], v[64:67]
    s_barrier
    ds_read_b64_tr_b16 a[144:145], v28 offset:0
    ds_read_b64_tr_b16 a[146:147], v28 offset:1024
    v_mfma_f32_16x16x32_bf16 v[68:71], a[184:187], a[124:127], v[68:71]
    ds_read_b128 a[128:131], v45 offset:40960
    v_mfma_f32_16x16x32_bf16 v[72:75], a[188:191], a[120:123], v[72:75]
    ds_read_b64_tr_b16 a[148:149], v29 offset:0
    buffer_load_dwordx4 v8, s[8:11], s36 offen offset:2048 lds
    v_mfma_f32_16x16x32_bf16 v[76:79], a[188:191], a[124:127], v[76:79]
    ds_read_b64_tr_b16 a[150:151], v29 offset:1024
    v_mfma_f32_16x16x32_bf16 v[80:83], a[192:195], a[120:123], v[80:83]
    ds_read_b128 a[132:135], v45 offset:43008
    v_mfma_f32_16x16x32_bf16 v[84:87], a[192:195], a[124:127], v[84:87]
    ds_read_b64_tr_b16 a[152:153], v30 offset:0
    v_mfma_f32_16x16x32_bf16 v[88:91], a[196:199], a[120:123], v[88:91]
    ds_read_b64_tr_b16 a[154:155], v30 offset:1024
    v_mfma_f32_16x16x32_bf16 v[92:95], a[196:199], a[124:127], v[92:95]
    ds_read_b64_tr_b16 a[156:157], v31 offset:0
    buffer_load_dwordx4 v9, s[8:11], s36 offen offset:3072 lds
    s_add_u32 m0, s38, 106496
    s_waitcnt lgkmcnt(9)
    v_mfma_f32_16x16x32_bf16 v[96:99], a[200:203], a[120:123], v[96:99]
    ds_read_b64_tr_b16 a[158:159], v31 offset:1024
    ds_read_b64_tr_b16 a[160:161], v32 offset:0
    v_mfma_f32_16x16x32_bf16 v[100:103], a[200:203], a[124:127], v[100:103]
    ds_read_b64_tr_b16 a[162:163], v32 offset:1024
    v_mfma_f32_16x16x32_bf16 v[104:107], a[204:207], a[120:123], v[104:107]
    ds_read_b64_tr_b16 a[164:165], v33 offset:0
    v_mfma_f32_16x16x32_bf16 v[108:111], a[204:207], a[124:127], v[108:111]
    ds_read_b64_tr_b16 a[166:167], v33 offset:1024
    buffer_load_dwordx4 v10, s[8:11], s36 offen lds
    s_add_u32 s36, s35, s47
    s_add_u32 m0, s38, 20480
    v_mfma_f32_16x16x32_bf16 v[112:115], a[208:211], a[120:123], v[112:115]
    ds_read_b64_tr_b16 a[168:169], v34 offset:0
    v_mfma_f32_16x16x32_bf16 v[116:119], a[208:211], a[124:127], v[116:119]
    ds_read_b64_tr_b16 a[170:171], v34 offset:1024
    v_mfma_f32_16x16x32_bf16 v[120:123], a[212:215], a[120:123], v[120:123]
    ds_read_b64_tr_b16 a[172:173], v35 offset:0
    v_mfma_f32_16x16x32_bf16 v[124:127], a[212:215], a[124:127], v[124:127]
    ds_read_b64_tr_b16 a[174:175], v35 offset:1024
    s_waitcnt lgkmcnt(8)
    v_mfma_f32_16x16x32_bf16 v[64:67], a[144:147], a[128:131], v[64:67]
    ds_read_b64_tr_b16 a[184:185], v28 offset:8192
    ds_read_b64_tr_b16 a[186:187], v28 offset:9216
    buffer_load_dwordx4 v6, s[8:11], s36 offen offset:0 lds
    v_mfma_f32_16x16x32_bf16 v[68:71], a[144:147], a[132:135], v[68:71]
    ds_read_b128 a[136:139], v46 offset:40960
    s_waitcnt vmcnt(14)
    v_mfma_f32_16x16x32_bf16 v[72:75], a[148:151], a[128:131], v[72:75]
    ds_read_b64_tr_b16 a[188:189], v29 offset:8192
    v_cmp_eq_u32 vcc, 0, v51
    s_nop 1
    s_cbranch_vccnz L_nonce_1_slow
L_nonce_1_back:
    v_mfma_f32_16x16x32_bf16 v[76:79], a[148:151], a[132:135], v[76:79]
    ds_read_b64_tr_b16 a[190:191], v29 offset:9216
    v_readfirstlane_b32 s43, v51
    s_nop 3
    v_mfma_f32_16x16x32_bf16 v[80:83], a[152:155], a[128:131], v[80:83]
    ds_read_b128 a[140:143], v46 offset:43008
    buffer_load_dwordx4 v7, s[8:11], s36 offen offset:1024 lds
    v_mfma_f32_16x16x32_bf16 v[84:87], a[152:155], a[132:135], v[84:87]
    ds_read_b64_tr_b16 a[192:193], v30 offset:8192
    v_mov_b32 v52, s43
    v_mfma_f32_16x16x32_bf16 v[88:91], a[156:159], a[128:131], v[88:91]
    ds_read_b64_tr_b16 a[194:195], v30 offset:9216
    v_mfma_f32_16x16x32_bf16 v[92:95], a[156:159], a[132:135], v[92:95]
    ds_read_b64_tr_b16 a[196:197], v31 offset:8192
    s_waitcnt lgkmcnt(9)
    v_mfma_f32_16x16x32_bf16 v[96:99], a[160:163], a[128:131], v[96:99]
    ds_read_b64_tr_b16 a[198:199], v31 offset:9216
    ds_read_b64_tr_b16 a[200:201], v32 offset:8192
    v_mfma_f32_16x16x32_bf16 v[100:103], a[160:163], a[132:135], v[100:103]
    ds_read_b64_tr_b16 a[202:203], v32 offset:9216
    buffer_load_dwordx4 v8, s[8:11], s36 offen offset:2048 lds
    v_mfma_f32_16x16x32_bf16 v[104:107], a[164:167], a[128:131], v[104:107]
    ds_read_b64_tr_b16 a[204:205], v33 offset:8192
    v_mfma_f32_16x16x32_bf16 v[108:111], a[164:167], a[132:135], v[108:111]
    ds_read_b64_tr_b16 a[206:207], v33 offset:9216
    v_mfma_f32_16x16x32_bf16 v[112:115], a[168:171], a[128:131], v[112:115]
    ds_read_b64_tr_b16 a[208:209], v34 offset:8192
    v_mfma_f32_16x16x32_bf16 v[116:119], a[168:171], a[132:135], v[116:119]
    ds_read_b64_tr_b16 a[210:211], v34 offset:9216
    buffer_load_dwordx4 v9, s[8:11], s36 offen offset:3072 lds
    s_add_u32 m0, s38, 24576
    v_mfma_f32_16x16x32_bf16 v[120:123], a[172:175], a[128:131], v[120:123]
    ds_read_b64_tr_b16 a[212:213], v35 offset:8192
    v_mfma_f32_16x16x32_bf16 v[124:127], a[172:175], a[132:135], v[124:127]
    ds_read_b64_tr_b16 a[214:215], v35 offset:9216
    s_waitcnt lgkmcnt(8)
    s_waitcnt vmcnt(14)
    v_mfma_f32_16x16x32_bf16 v[64:67], a[184:187], a[136:139], v[64:67]
    s_barrier
    ds_read_b64_tr_b16 a[144:145], v38 offset:20480
    ds_read_b64_tr_b16 a[146:147], v38 offset:21760
    v_mfma_f32_16x16x32_bf16 v[68:71], a[184:187], a[140:143], v[68:71]
    ds_read_b64_tr_b16 a[148:149], v39 offset:20512
    v_mfma_f32_16x16x32_bf16 v[72:75], a[188:191], a[136:139], v[72:75]
    ds_read_b64_tr_b16 a[150:151], v39 offset:21792
    buffer_load_dwordx4 v10, s[8:11], s36 offen lds
    s_add_u32 s36, s35, s48
    s_add_u32 m0, s38, 122880
    v_mfma_f32_16x16x32_bf16 v[76:79], a[188:191], a[140:143], v[76:79]
    ds_read_b64_tr_b16 a[152:153], v38 offset:20544
    v_mfma_f32_16x16x32_bf16 v[80:83], a[192:195], a[136:139], v[80:83]
    ds_read_b64_tr_b16 a[154:155], v38 offset:21824
    ds_read_b64_tr_b16 a[156:157], v39 offset:20576
    v_mfma_f32_16x16x32_bf16 v[84:87], a[192:195], a[140:143], v[84:87]
    ds_read_b64_tr_b16 a[158:159], v39 offset:21856
    v_mfma_f32_16x16x32_bf16 v[88:91], a[196:199], a[136:139], v[88:91]
    ds_read_b64_tr_b16 a[160:161], v38 offset:20608
    buffer_load_dwordx4 v6, s[8:11], s36 offen offset:0 lds
    v_mfma_f32_16x16x32_bf16 v[92:95], a[196:199], a[140:143], v[92:95]
    ds_read_b64_tr_b16 a[162:163], v38 offset:21888
    s_waitcnt lgkmcnt(10)
    v_mfma_f32_16x16x32_bf16 v[96:99], a[200:203], a[136:139], v[96:99]
    ds_read_b64_tr_b16 a[164:165], v39 offset:20640
    ds_read_b64_tr_b16 a[166:167], v39 offset:21920
    v_mfma_f32_16x16x32_bf16 v[100:103], a[200:203], a[140:143], v[100:103]
    ds_read_b64_tr_b16 a[168:169], v38 offset:20672
    v_mfma_f32_16x16x32_bf16 v[104:107], a[204:207], a[136:139], v[104:107]
    ds_read_b64_tr_b16 a[170:171], v38 offset:21952
    v_mfma_f32_16x16x32_bf16 v[108:111], a[204:207], a[140:143], v[108:111]
    ds_read_b64_tr_b16 a[172:173], v39 offset:20704
    buffer_load_dwordx4 v7, s[8:11], s36 offen offset:1024 lds
    v_mfma_f32_16x16x32_bf16 v[112:115], a[208:211], a[136:139], v[112:115]
    ds_read_b64_tr_b16 a[174:175], v39 offset:21984
    ds_read_b64_tr_b16 a[176:177], v38 offset:20736
    v_mfma_f32_16x16x32_bf16 v[116:119], a[208:211], a[140:143], v[116:119]
    ds_read_b64_tr_b16 a[178:179], v38 offset:22016
    v_mfma_f32_16x16x32_bf16 v[120:123], a[212:215], a[136:139], v[120:123]
    ds_read_b64_tr_b16 a[180:181], v39 offset:20768
    v_mfma_f32_16x16x32_bf16 v[124:127], a[212:215], a[140:143], v[124:127]
    ds_read_b64_tr_b16 a[182:183], v39 offset:22048
    buffer_load_dwordx4 v8, s[8:11], s36 offen offset:2048 lds
    s_waitcnt lgkmcnt(10)
    v_mfma_f32_16x16x32_bf16 v[128:131], a[144:147], a[0:3], v[208:211]
    ds_read_b64_tr_b16 a[184:185], v38 offset:30720
    v_mfma_f32_16x16x32_bf16 v[132:135], a[144:147], a[4:7], v[208:211]
    ds_read_b64_tr_b16 a[186:187], v38 offset:32000
    v_mfma_f32_16x16x32_bf16 v[136:139], a[148:151], a[0:3], v[212:215]
    ds_read_b64_tr_b16 a[188:189], v39 offset:30752
    v_mfma_f32_16x16x32_bf16 v[140:143], a[148:151], a[4:7], v[212:215]
    ds_read_b64_tr_b16 a[190:191], v39 offset:32032
    v_mfma_f32_16x16x32_bf16 v[144:147], a[152:155], a[0:3], v[216:219]
    ds_read_b64_tr_b16 a[192:193], v38 offset:30784
    buffer_load_dwordx4 v9, s[8:11], s36 offen offset:3072 lds
    s_add_u32 m0, s38, 126976
    v_mfma_f32_16x16x32_bf16 v[148:151], a[152:155], a[4:7], v[216:219]
    ds_read_b64_tr_b16 a[194:195], v38 offset:32064
    v_mfma_f32_16x16x32_bf16 v[152:155], a[156:159], a[0:3], v[220:223]
    ds_read_b64_tr_b16 a[196:197], v39 offset:30816
    v_mfma_f32_16x16x32_bf16 v[156:159], a[156:159], a[4:7], v[220:223]
    ds_read_b64_tr_b16 a[198:199], v39 offset:32096
    v_mfma_f32_16x16x32_bf16 v[160:163], a[160:163], a[0:3], v[224:227]
    ds_read_b64_tr_b16 a[200:201], v38 offset:30848
    buffer_load_dwordx4 v10, s[8:11], s36 offen lds
    s_add_u32 s36, s35, s49
    s_add_u32 m0, s38, 40960
    v_mul_f32 v64, v64, |v64|
    v_mfma_f32_16x16x32_bf16 v[164:167], a[160:163], a[4:7], v[224:227]
    ds_read_b64_tr_b16 a[202:203], v38 offset:32128
    v_mul_f32 v65, v65, |v65|
    s_waitcnt lgkmcnt(10)
    v_mfma_f32_16x16x32_bf16 v[168:171], a[164:167], a[0:3], v[228:231]
    ds_read_b64_tr_b16 a[204:205], v39 offset:30880
    v_mul_f32 v66, v66, |v66|
    v_mfma_f32_16x16x32_bf16 v[172:175], a[164:167], a[4:7], v[228:231]
    ds_read_b64_tr_b16 a[206:207], v39 offset:32160
    v_mul_f32 v67, v67, |v67|
    v_mfma_f32_16x16x32_bf16 v[176:179], a[168:171], a[0:3], v[232:235]
    ds_read_b64_tr_b16 a[208:209], v38 offset:30912
    v_mul_f32 v72, v72, |v72|
    v_mfma_f32_16x16x32_bf16 v[180:183], a[168:171], a[4:7], v[232:235]
    ds_read_b64_tr_b16 a[210:211], v38 offset:32192
    buffer_load_dwordx4 v6, s[8:11], s36 offen offset:0 lds
    v_mul_f32 v73, v73, |v73|
    v_mfma_f32_16x16x32_bf16 v[184:187], a[172:175], a[0:3], v[236:239]
    ds_read_b64_tr_b16 a[212:213], v39 offset:30944
    v_mul_f32 v74, v74, |v74|
    v_mfma_f32_16x16x32_bf16 v[188:191], a[172:175], a[4:7], v[236:239]
    ds_read_b64_tr_b16 a[214:215], v39 offset:32224
    v_mul_f32 v75, v75, |v75|
    v_mfma_f32_16x16x32_bf16 v[192:195], a[176:179], a[0:3], v[240:243]
    ds_read_b64_tr_b16 a[216:217], v38 offset:30976
    v_cvt_pk_bf16_f32 v64, v64, v65
    v_mfma_f32_16x16x32_bf16 v[196:199], a[176:179], a[4:7], v[240:243]
    ds_read_b64_tr_b16 a[218:219], v38 offset:32256
    buffer_load_dwordx4 v7, s[8:11], s36 offen offset:1024 lds
    v_cvt_pk_bf16_f32 v65, v66, v67
    v_mfma_f32_16x16x32_bf16 v[200:203], a[180:183], a[0:3], v[244:247]
    ds_read_b64_tr_b16 a[220:221], v39 offset:31008
    v_cvt_pk_bf16_f32 v66, v72, v73
    v_mfma_f32_16x16x32_bf16 v[204:207], a[180:183], a[4:7], v[244:247]
    ds_read_b64_tr_b16 a[222:223], v39 offset:32288
    v_cvt_pk_bf16_f32 v67, v74, v75
    s_waitcnt lgkmcnt(10)
    s_waitcnt vmcnt(17)
    v_mfma_f32_16x16x32_bf16 v[128:131], a[184:187], a[8:11], v[128:131]
    s_barrier
    ds_read_b64_tr_b16 a[144:145], v36 offset:0
    v_pk_max_i16 v64, v64, 0
    v_mfma_f32_16x16x32_bf16 v[132:135], a[184:187], a[12:15], v[132:135]
    ds_read_b64_tr_b16 a[146:147], v36 offset:1280
    v_pk_max_i16 v65, v65, 0
    v_mfma_f32_16x16x32_bf16 v[136:139], a[188:191], a[8:11], v[136:139]
    ds_read_b64_tr_b16 a[148:149], v37 offset:32
    buffer_load_dwordx4 v8, s[8:11], s36 offen offset:2048 lds
    v_pk_max_i16 v66, v66, 0
    v_mfma_f32_16x16x32_bf16 v[140:143], a[188:191], a[12:15], v[140:143]
    ds_read_b64_tr_b16 a[150:151], v37 offset:1312
    s_add_u32 s42, s40, 0
    v_pk_max_i16 v67, v67, 0
    v_mul_f32 v68, v68, |v68|
    v_mfma_f32_16x16x32_bf16 v[144:147], a[192:195], a[8:11], v[144:147]
    ds_read_b64_tr_b16 a[152:153], v36 offset:64
    v_mul_f32 v69, v69, |v69|
    v_mfma_f32_16x16x32_bf16 v[148:151], a[192:195], a[12:15], v[148:151]
    ds_read_b64_tr_b16 a[154:155], v36 offset:1344
    v_mul_f32 v70, v70, |v70|
    v_mfma_f32_16x16x32_bf16 v[152:155], a[196:199], a[8:11], v[152:155]
    ds_read_b64_tr_b16 a[156:157], v37 offset:96
    buffer_store_dwordx4 v[64:67], v47, s[16:19], s42 offen offset:0 sc1
    v_mul_f32 v71, v71, |v71|
    v_mfma_f32_16x16x32_bf16 v[156:159], a[196:199], a[12:15], v[156:159]
    ds_read_b64_tr_b16 a[158:159], v37 offset:1376
    v_mul_f32 v76, v76, |v76|
    v_mfma_f32_16x16x32_bf16 v[160:163], a[200:203], a[8:11], v[160:163]
    ds_read_b64_tr_b16 a[160:161], v36 offset:128
    v_mul_f32 v77, v77, |v77|
    v_mfma_f32_16x16x32_bf16 v[164:167], a[200:203], a[12:15], v[164:167]
    ds_read_b64_tr_b16 a[162:163], v36 offset:1408
    v_mul_f32 v78, v78, |v78|
    s_waitcnt lgkmcnt(10)
    v_mfma_f32_16x16x32_bf16 v[168:171], a[204:207], a[8:11], v[168:171]
    ds_read_b64_tr_b16 a[164:165], v37 offset:160
    buffer_load_dwordx4 v9, s[8:11], s36 offen offset:3072 lds
    s_add_u32 m0, s38, 45056
    v_mul_f32 v79, v79, |v79|
    v_mfma_f32_16x16x32_bf16 v[172:175], a[204:207], a[12:15], v[172:175]
    ds_read_b64_tr_b16 a[166:167], v37 offset:1440
    v_cvt_pk_bf16_f32 v68, v68, v69
    v_mfma_f32_16x16x32_bf16 v[176:179], a[208:211], a[8:11], v[176:179]
    ds_read_b64_tr_b16 a[168:169], v36 offset:192
    v_cvt_pk_bf16_f32 v69, v70, v71
    v_mfma_f32_16x16x32_bf16 v[180:183], a[208:211], a[12:15], v[180:183]
    ds_read_b64_tr_b16 a[170:171], v36 offset:1472
    v_cvt_pk_bf16_f32 v70, v76, v77
    v_mfma_f32_16x16x32_bf16 v[184:187], a[212:215], a[8:11], v[184:187]
    ds_read_b64_tr_b16 a[172:173], v37 offset:224
    buffer_load_dwordx4 v10, s[8:11], s36 offen lds
    s_add_u32 s36, s35, s50
    s_add_u32 m0, s38, 143360
    v_cvt_pk_bf16_f32 v71, v78, v79
    v_mfma_f32_16x16x32_bf16 v[188:191], a[212:215], a[12:15], v[188:191]
    ds_read_b64_tr_b16 a[174:175], v37 offset:1504
    v_pk_max_i16 v68, v68, 0
    v_mfma_f32_16x16x32_bf16 v[192:195], a[216:219], a[8:11], v[192:195]
    ds_read_b64_tr_b16 a[176:177], v36 offset:256
    v_pk_max_i16 v69, v69, 0
    v_mfma_f32_16x16x32_bf16 v[196:199], a[216:219], a[12:15], v[196:199]
    ds_read_b64_tr_b16 a[178:179], v36 offset:1536
    v_pk_max_i16 v70, v70, 0
    v_mfma_f32_16x16x32_bf16 v[200:203], a[220:223], a[8:11], v[200:203]
    ds_read_b64_tr_b16 a[180:181], v37 offset:288
    v_pk_max_i16 v71, v71, 0
    v_mul_f32 v80, v80, |v80|
    v_mfma_f32_16x16x32_bf16 v[204:207], a[220:223], a[12:15], v[204:207]
    ds_read_b64_tr_b16 a[182:183], v37 offset:1568
    buffer_store_dwordx4 v[68:71], v47, s[16:19], s42 offen offset:1024 sc1
    v_mul_f32 v81, v81, |v81|
    s_waitcnt lgkmcnt(10)
    v_mfma_f32_16x16x32_bf16 v[128:131], a[144:147], a[16:19], v[128:131]
    ds_read_b64_tr_b16 a[184:185], v36 offset:10240
    v_mul_f32 v82, v82, |v82|
    v_mfma_f32_16x16x32_bf16 v[132:135], a[144:147], a[20:23], v[132:135]
    ds_read_b64_tr_b16 a[186:187], v36 offset:11520
    v_mul_f32 v83, v83, |v83|
    v_mfma_f32_16x16x32_bf16 v[136:139], a[148:151], a[16:19], v[136:139]
    ds_read_b64_tr_b16 a[188:189], v37 offset:10272
    buffer_load_dwordx4 v6, s[8:11], s36 offen offset:0 lds
    v_mul_f32 v88, v88, |v88|
    v_mfma_f32_16x16x32_bf16 v[140:143], a[148:151], a[20:23], v[140:143]
    ds_read_b64_tr_b16 a[190:191], v37 offset:11552
    v_mul_f32 v89, v89, |v89|
    v_mfma_f32_16x16x32_bf16 v[144:147], a[152:155], a[16:19], v[144:147]
    ds_read_b64_tr_b16 a[192:193], v36 offset:10304
    v_mul_f32 v90, v90, |v90|
    v_mfma_f32_16x16x32_bf16 v[148:151], a[152:155], a[20:23], v[148:151]
    ds_read_b64_tr_b16 a[194:195], v36 offset:11584
    v_mul_f32 v91, v91, |v91|
    v_mfma_f32_16x16x32_bf16 v[152:155], a[156:159], a[16:19], v[152:155]
    ds_read_b64_tr_b16 a[196:197], v37 offset:10336
    v_cvt_pk_bf16_f32 v80, v80, v81
    v_mfma_f32_16x16x32_bf16 v[156:159], a[156:159], a[20:23], v[156:159]
    ds_read_b64_tr_b16 a[198:199], v37 offset:11616
    buffer_load_dwordx4 v7, s[8:11], s36 offen offset:1024 lds
    v_cvt_pk_bf16_f32 v81, v82, v83
    v_mfma_f32_16x16x32_bf16 v[160:163], a[160:163], a[16:19], v[160:163]
    ds_read_b64_tr_b16 a[200:201], v36 offset:10368
    v_cvt_pk_bf16_f32 v82, v88, v89
    v_mfma_f32_16x16x32_bf16 v[164:167], a[160:163], a[20:23], v[164:167]
    ds_read_b64_tr_b16 a[202:203], v36 offset:11648
    v_cvt_pk_bf16_f32 v83, v90, v91
    s_waitcnt lgkmcnt(10)
    v_mfma_f32_16x16x32_bf16 v[168:171], a[164:167], a[16:19], v[168:171]
    ds_read_b64_tr_b16 a[204:205], v37 offset:10400
    v_pk_max_i16 v80, v80, 0
    v_mfma_f32_16x16x32_bf16 v[172:175], a[164:167], a[20:23], v[172:175]
    ds_read_b64_tr_b16 a[206:207], v37 offset:11680
    buffer_load_dwordx4 v8, s[8:11], s36 offen offset:2048 lds
    v_pk_max_i16 v81, v81, 0
    v_mfma_f32_16x16x32_bf16 v[176:179], a[168:171], a[16:19], v[176:179]
    ds_read_b64_tr_b16 a[208:209], v36 offset:10432
    v_pk_max_i16 v82, v82, 0
    v_mfma_f32_16x16x32_bf16 v[180:183], a[168:171], a[20:23], v[180:183]
    ds_read_b64_tr_b16 a[210:211], v36 offset:11712
    s_add_u32 s42, s40, 8192
    v_pk_max_i16 v83, v83, 0
    v_mul_f32 v84, v84, |v84|
    v_mfma_f32_16x16x32_bf16 v[184:187], a[172:175], a[16:19], v[184:187]
    ds_read_b64_tr_b16 a[212:213], v37 offset:10464
    v_mul_f32 v85, v85, |v85|
    v_mfma_f32_16x16x32_bf16 v[188:191], a[172:175], a[20:23], v[188:191]
    ds_read_b64_tr_b16 a[214:215], v37 offset:11744
    v_mul_f32 v86, v86, |v86|
    v_mfma_f32_16x16x32_bf16 v[192:195], a[176:179], a[16:19], v[192:195]
    ds_read_b64_tr_b16 a[216:217], v36 offset:10496
    buffer_store_dwordx4 v[80:83], v47, s[16:19], s42 offen offset:0 sc1
    v_mul_f32 v87, v87, |v87|
    v_mfma_f32_16x16x32_bf16 v[196:199], a[176:179], a[20:23], v[196:199]
    ds_read_b64_tr_b16 a[218:219], v36 offset:11776
    v_mul_f32 v92, v92, |v92|
    v_mfma_f32_16x16x32_bf16 v[200:203], a[180:183], a[16:19], v[200:203]
    ds_read_b64_tr_b16 a[220:221], v37 offset:10528
    v_mul_f32 v93, v93, |v93|
    v_mfma_f32_16x16x32_bf16 v[204:207], a[180:183], a[20:23], v[204:207]
    ds_read_b64_tr_b16 a[222:223], v37 offset:11808
    buffer_load_dwordx4 v9, s[8:11], s36 offen offset:3072 lds
    s_add_u32 m0, s38, 147456
    v_mul_f32 v94, v94, |v94|
    s_waitcnt lgkmcnt(10)
    s_waitcnt vmcnt(22)
    v_mfma_f32_16x16x32_bf16 v[128:131], a[184:187], a[24:27], v[128:131]
    s_barrier
    ds_read_b64_tr_b16 a[144:145], v38 offset:40960
    v_mul_f32 v95, v95, |v95|
    v_mfma_f32_16x16x32_bf16 v[132:135], a[184:187], a[28:31], v[132:135]
    ds_read_b64_tr_b16 a[146:147], v38 offset:42240
    v_cvt_pk_bf16_f32 v84, v84, v85
    v_mfma_f32_16x16x32_bf16 v[136:139], a[188:191], a[24:27], v[136:139]
    ds_read_b64_tr_b16 a[148:149], v39 offset:40992
    v_cvt_pk_bf16_f32 v85, v86, v87
    v_mfma_f32_16x16x32_bf16 v[140:143], a[188:191], a[28:31], v[140:143]
    ds_read_b64_tr_b16 a[150:151], v39 offset:42272
    v_cvt_pk_bf16_f32 v86, v92, v93
    s_and_b32 s100, s29, 7
    v_mfma_f32_16x16x32_bf16 v[144:147], a[192:195], a[24:27], v[144:147]
    ds_read_b64_tr_b16 a[152:153], v38 offset:41024
    buffer_load_dwordx4 v10, s[8:11], s36 offen lds
    s_add_u32 s36, s35, s51
    s_add_u32 m0, s38, 61440
    v_cvt_pk_bf16_f32 v87, v94, v95
    s_lshl_b32 s100, s100, 2
    v_mfma_f32_16x16x32_bf16 v[148:151], a[192:195], a[28:31], v[148:151]
    ds_read_b64_tr_b16 a[154:155], v38 offset:42304
    v_pk_max_i16 v84, v84, 0
    s_add_u32 s100, s100, s33
    v_mfma_f32_16x16x32_bf16 v[152:155], a[196:199], a[24:27], v[152:155]
    ds_read_b64_tr_b16 a[156:157], v39 offset:41056
    v_pk_max_i16 v85, v85, 0
    s_mul_i32 s100, s100, 41472
    v_mfma_f32_16x16x32_bf16 v[156:159], a[196:199], a[28:31], v[156:159]
    ds_read_b64_tr_b16 a[158:159], v39 offset:42336
    v_pk_max_i16 v86, v86, 0
    s_mul_i32 s101, s32, 1327104
    v_mfma_f32_16x16x32_bf16 v[160:163], a[200:203], a[24:27], v[160:163]
    ds_read_b64_tr_b16 a[160:161], v38 offset:41088
    buffer_load_dwordx4 v6, s[8:11], s36 offen offset:0 lds
    v_pk_max_i16 v87, v87, 0
    v_mul_f32 v96, v96, |v96|
    s_add_u32 s100, s100, s101
    v_mfma_f32_16x16x32_bf16 v[164:167], a[200:203], a[28:31], v[164:167]
    ds_read_b64_tr_b16 a[162:163], v38 offset:42368
    v_mul_f32 v97, v97, |v97|
    s_mul_i32 s101, s28, 10368
    s_waitcnt lgkmcnt(10)
    v_mfma_f32_16x16x32_bf16 v[168:171], a[204:207], a[24:27], v[168:171]
    ds_read_b64_tr_b16 a[164:165], v39 offset:41120
    v_mul_f32 v98, v98, |v98|
    s_add_u32 s100, s100, s101
    v_mfma_f32_16x16x32_bf16 v[172:175], a[204:207], a[28:31], v[172:175]
    ds_read_b64_tr_b16 a[166:167], v39 offset:42400
    v_mul_f32 v99, v99, |v99|
    v_lshlrev_b32 v53, 7, v1
    v_mfma_f32_16x16x32_bf16 v[176:179], a[208:211], a[24:27], v[176:179]
    ds_read_b64_tr_b16 a[168:169], v38 offset:41152
    v_mul_f32 v104, v104, |v104|
    v_mov_b32 v55, 1073741824
    v_mfma_f32_16x16x32_bf16 v[180:183], a[208:211], a[28:31], v[180:183]
    ds_read_b64_tr_b16 a[170:171], v38 offset:42432
    buffer_store_dwordx4 v[84:87], v47, s[16:19], s42 offen offset:1024 sc1
    v_mul_f32 v105, v105, |v105|
    v_add_u32 v54, 8192, v53
    v_mfma_f32_16x16x32_bf16 v[184:187], a[212:215], a[24:27], v[184:187]
    ds_read_b64_tr_b16 a[172:173], v39 offset:41184
    v_mul_f32 v106, v106, |v106|
    v_cmp_gt_u32 vcc, 17, v1
    s_nop 1
    v_cndmask_b32 v54, v55, v54, vcc
    v_mfma_f32_16x16x32_bf16 v[188:191], a[212:215], a[28:31], v[188:191]
    ds_read_b64_tr_b16 a[174:175], v39 offset:42464
    v_mul_f32 v107, v107, |v107|
    v_mfma_f32_16x16x32_bf16 v[192:195], a[216:219], a[24:27], v[192:195]
    ds_read_b64_tr_b16 a[176:177], v38 offset:41216
    buffer_load_dwordx4 v7, s[8:11], s36 offen offset:1024 lds
    v_cvt_pk_bf16_f32 v96, v96, v97
    v_mfma_f32_16x16x32_bf16 v[196:199], a[216:219], a[28:31], v[196:199]
    ds_read_b64_tr_b16 a[178:179], v38 offset:42496
    v_cvt_pk_bf16_f32 v97, v98, v99
    v_mfma_f32_16x16x32_bf16 v[200:203], a[220:223], a[24:27], v[200:203]
    ds_read_b64_tr_b16 a[180:181], v39 offset:41248
    v_cvt_pk_bf16_f32 v98, v104, v105
    v_mfma_f32_16x16x32_bf16 v[204:207], a[220:223], a[28:31], v[204:207]
    ds_read_b64_tr_b16 a[182:183], v39 offset:42528
    v_cvt_pk_bf16_f32 v99, v106, v107
    s_waitcnt lgkmcnt(10)
    v_mfma_f32_16x16x32_bf16 v[128:131], a[144:147], a[32:35], v[128:131]
    ds_read_b64_tr_b16 a[184:185], v38 offset:51200
    v_pk_max_i16 v96, v96, 0
    v_mfma_f32_16x16x32_bf16 v[132:135], a[144:147], a[36:39], v[132:135]
    ds_read_b64_tr_b16 a[186:187], v38 offset:52480
    buffer_load_dwordx4 v8, s[8:11], s36 offen offset:2048 lds
    v_pk_max_i16 v97, v97, 0
    v_mfma_f32_16x16x32_bf16 v[136:139], a[148:151], a[32:35], v[136:139]
    ds_read_b64_tr_b16 a[188:189], v39 offset:51232
    v_pk_max_i16 v98, v98, 0
    v_mfma_f32_16x16x32_bf16 v[140:143], a[148:151], a[36:39], v[140:143]
    ds_read_b64_tr_b16 a[190:191], v39 offset:52512
    s_add_u32 s42, s40, 16384
    v_pk_max_i16 v99, v99, 0
    v_mul_f32 v100, v100, |v100|
    v_mfma_f32_16x16x32_bf16 v[144:147], a[152:155], a[32:35], v[144:147]
    ds_read_b64_tr_b16 a[192:193], v38 offset:51264
    v_mul_f32 v101, v101, |v101|
    v_mfma_f32_16x16x32_bf16 v[148:151], a[152:155], a[36:39], v[148:151]
    ds_read_b64_tr_b16 a[194:195], v38 offset:52544
    buffer_store_dwordx4 v[96:99], v47, s[16:19], s42 offen offset:0 sc1
    v_mul_f32 v102, v102, |v102|
    v_mfma_f32_16x16x32_bf16 v[152:155], a[156:159], a[32:35], v[152:155]
    ds_read_b64_tr_b16 a[196:197], v39 offset:51296
    v_mul_f32 v103, v103, |v103|
    v_mfma_f32_16x16x32_bf16 v[156:159], a[156:159], a[36:39], v[156:159]
    ds_read_b64_tr_b16 a[198:199], v39 offset:52576
    v_mul_f32 v108, v108, |v108|
    v_mfma_f32_16x16x32_bf16 v[160:163], a[160:163], a[32:35], v[160:163]
    ds_read_b64_tr_b16 a[200:201], v38 offset:51328
    v_mul_f32 v109, v109, |v109|
    v_mfma_f32_16x16x32_bf16 v[164:167], a[160:163], a[36:39], v[164:167]
    ds_read_b64_tr_b16 a[202:203], v38 offset:52608
    buffer_load_dwordx4 v9, s[8:11], s36 offen offset:3072 lds
    s_add_u32 m0, s38, 65536
    v_mul_f32 v110, v110, |v110|
    s_waitcnt lgkmcnt(10)
    v_mfma_f32_16x16x32_bf16 v[168:171], a[164:167], a[32:35], v[168:171]
    ds_read_b64_tr_b16 a[204:205], v39 offset:51360
    v_mul_f32 v111, v111, |v111|
    v_mfma_f32_16x16x32_bf16 v[172:175], a[164:167], a[36:39], v[172:175]
    ds_read_b64_tr_b16 a[206:207], v39 offset:52640
    v_cvt_pk_bf16_f32 v100, v100, v101
    v_mfma_f32_16x16x32_bf16 v[176:179], a[168:171], a[32:35], v[176:179]
    ds_read_b64_tr_b16 a[208:209], v38 offset:51392
    v_cvt_pk_bf16_f32 v101, v102, v103
    v_mfma_f32_16x16x32_bf16 v[180:183], a[168:171], a[36:39], v[180:183]
    ds_read_b64_tr_b16 a[210:211], v38 offset:52672
    buffer_load_dwordx4 v10, s[8:11], s36 offen lds
    s_add_u32 s36, s35, s52
    s_add_u32 m0, s38, 81920
    v_cvt_pk_bf16_f32 v102, v108, v109
    v_mfma_f32_16x16x32_bf16 v[184:187], a[172:175], a[32:35], v[184:187]
    ds_read_b64_tr_b16 a[212:213], v39 offset:51424
    v_cvt_pk_bf16_f32 v103, v110, v111
    v_mfma_f32_16x16x32_bf16 v[188:191], a[172:175], a[36:39], v[188:191]
    ds_read_b64_tr_b16 a[214:215], v39 offset:52704
    v_pk_max_i16 v100, v100, 0
    v_mfma_f32_16x16x32_bf16 v[192:195], a[176:179], a[32:35], v[192:195]
    ds_read_b64_tr_b16 a[216:217], v38 offset:51456
    v_pk_max_i16 v101, v101, 0
    v_mfma_f32_16x16x32_bf16 v[196:199], a[176:179], a[36:39], v[196:199]
    ds_read_b64_tr_b16 a[218:219], v38 offset:52736
    v_pk_max_i16 v102, v102, 0
    v_mfma_f32_16x16x32_bf16 v[200:203], a[180:183], a[32:35], v[200:203]
    ds_read_b64_tr_b16 a[220:221], v39 offset:51488
    buffer_load_dwordx4 v6, s[8:11], s36 offen offset:0 lds
    v_pk_max_i16 v103, v103, 0
    v_mul_f32 v112, v112, |v112|
    v_mfma_f32_16x16x32_bf16 v[204:207], a[180:183], a[36:39], v[204:207]
    ds_read_b64_tr_b16 a[222:223], v39 offset:52768
    v_mul_f32 v113, v113, |v113|
    s_waitcnt lgkmcnt(10)
    s_waitcnt vmcnt(26)
    v_mfma_f32_16x16x32_bf16 v[128:131], a[184:187], a[40:43], v[128:131]
    s_barrier
    ds_read_b64_tr_b16 a[144:145], v36 offset:20480
    v_mul_f32 v114, v114, |v114|
    v_mfma_f32_16x16x32_bf16 v[132:135], a[184:187], a[44:47], v[132:135]
    ds_read_b64_tr_b16 a[146:147], v36 offset:21760
    v_mul_f32 v115, v115, |v115|
    v_mfma_f32_16x16x32_bf16 v[136:139], a[188:191], a[40:43], v[136:139]
    ds_read_b64_tr_b16 a[148:149], v37 offset:20512
    buffer_store_dwordx4 v[100:103], v47, s[16:19], s42 offen offset:1024 sc1
    v_mul_f32 v120, v120, |v120|
    v_mfma_f32_16x16x32_bf16 v[140:143], a[188:191], a[44:47], v[140:143]
    ds_read_b64_tr_b16 a[150:151], v37 offset:21792
    v_mul_f32 v121, v121, |v121|
    v_mfma_f32_16x16x32_bf16 v[144:147], a[192:195], a[40:43], v[144:147]
    ds_read_b64_tr_b16 a[152:153], v36 offset:20544
    v_mul_f32 v122, v122, |v122|
    v_mfma_f32_16x16x32_bf16 v[148:151], a[192:195], a[44:47], v[148:151]
    ds_read_b64_tr_b16 a[154:155], v36 offset:21824
    v_mul_f32 v123, v123, |v123|
    v_mfma_f32_16x16x32_bf16 v[152:155], a[196:199], a[40:43], v[152:155]
    ds_read_b64_tr_b16 a[156:157], v37 offset:20576
    buffer_load_dwordx4 v7, s[8:11], s36 offen offset:1024 lds
    v_cvt_pk_bf16_f32 v112, v112, v113
    v_mfma_f32_16x16x32_bf16 v[156:159], a[196:199], a[44:47], v[156:159]
    ds_read_b64_tr_b16 a[158:159], v37 offset:21856
    v_cvt_pk_bf16_f32 v113, v114, v115
    v_mfma_f32_16x16x32_bf16 v[160:163], a[200:203], a[40:43], v[160:163]
    ds_read_b64_tr_b16 a[160:161], v36 offset:20608
    v_cvt_pk_bf16_f32 v114, v120, v121
    v_mfma_f32_16x16x32_bf16 v[164:167], a[200:203], a[44:47], v[164:167]
    ds_read_b64_tr_b16 a[162:163], v36 offset:21888
    v_cvt_pk_bf16_f32 v115, v122, v123
    s_waitcnt lgkmcnt(10)
    v_mfma_f32_16x16x32_bf16 v[168:171], a[204:207], a[40:43], v[168:171]
    ds_read_b64_tr_b16 a[164:165], v37 offset:20640
    buffer_load_dwordx4 v8, s[8:11], s36 offen offset:2048 lds
    v_pk_max_i16 v112, v112, 0
    v_mfma_f32_16x16x32_bf16 v[172:175], a[204:207], a[44:47], v[172:175]
    ds_read_b64_tr_b16 a[166:167], v37 offset:21920
    v_pk_max_i16 v113, v113, 0
    v_mfma_f32_16x16x32_bf16 v[176:179], a[208:211], a[40:43], v[176:179]
    ds_read_b64_tr_b16 a[168:169], v36 offset:20672
    v_pk_max_i16 v114, v114, 0
    v_mfma_f32_16x16x32_bf16 v[180:183], a[208:211], a[44:47], v[180:183]
    ds_read_b64_tr_b16 a[170:171], v36 offset:21952
    s_add_u32 s42, s40, 24576
    v_pk_max_i16 v115, v115, 0
    v_mul_f32 v116, v116, |v116|
    v_mfma_f32_16x16x32_bf16 v[184:187], a[212:215], a[40:43], v[184:187]
    ds_read_b64_tr_b16 a[172:173], v37 offset:20704
    v_mul_f32 v117, v117, |v117|
    v_mfma_f32_16x16x32_bf16 v[188:191], a[212:215], a[44:47], v[188:191]
    ds_read_b64_tr_b16 a[174:175], v37 offset:21984
    buffer_store_dwordx4 v[112:115], v47, s[16:19], s42 offen offset:0 sc1
    v_mul_f32 v118, v118, |v118|
    v_mfma_f32_16x16x32_bf16 v[192:195], a[216:219], a[40:43], v[192:195]
    ds_read_b64_tr_b16 a[176:177], v36 offset:20736
    v_mul_f32 v119, v119, |v119|
    v_mfma_f32_16x16x32_bf16 v[196:199], a[216:219], a[44:47], v[196:199]
    ds_read_b64_tr_b16 a[178:179], v36 offset:22016
    v_mul_f32 v124, v124, |v124|
    v_mfma_f32_16x16x32_bf16 v[200:203], a[220:223], a[40:43], v[200:203]
    ds_read_b64_tr_b16 a[180:181], v37 offset:20768
    buffer_load_dwordx4 v9, s[8:11], s36 offen offset:3072 lds
    s_add_u32 m0, s38, 86016
    v_mul_f32 v125, v125, |v125|
    v_mfma_f32_16x16x32_bf16 v[204:207], a[220:223], a[44:47], v[204:207]
    ds_read_b64_tr_b16 a[182:183], v37 offset:22048
    v_mul_f32 v126, v126, |v126|
    s_waitcnt lgkmcnt(10)
    v_mfma_f32_16x16x32_bf16 v[128:131], a[144:147], a[48:51], v[128:131]
    ds_read_b64_tr_b16 a[184:185], v36 offset:30720
    v_mul_f32 v127, v127, |v127|
    v_mfma_f32_16x16x32_bf16 v[132:135], a[144:147], a[52:55], v[132:135]
    ds_read_b64_tr_b16 a[186:187], v36 offset:32000
    v_cvt_pk_bf16_f32 v116, v116, v117
    v_mfma_f32_16x16x32_bf16 v[136:139], a[148:151], a[48:51], v[136:139]
    ds_read_b64_tr_b16 a[188:189], v37 offset:30752
    v_cvt_pk_bf16_f32 v117, v118, v119
    v_mfma_f32_16x16x32_bf16 v[140:143], a[148:151], a[52:55], v[140:143]
    ds_read_b64_tr_b16 a[190:191], v37 offset:32032
    buffer_load_dwordx4 v10, s[8:11], s36 offen lds
    v_cvt_pk_bf16_f32 v118, v124, v125
    v_mfma_f32_16x16x32_bf16 v[144:147], a[152:155], a[48:51], v[144:147]
    ds_read_b64_tr_b16 a[192:193], v36 offset:30784
    v_cvt_pk_bf16_f32 v119, v126, v127
    v_mfma_f32_16x16x32_bf16 v[148:151], a[152:155], a[52:55], v[148:151]
    ds_read_b64_tr_b16 a[194:195], v36 offset:32064
    v_pk_max_i16 v116, v116, 0
    v_mfma_f32_16x16x32_bf16 v[152:155], a[156:159], a[48:51], v[152:155]
    ds_read_b64_tr_b16 a[196:197], v37 offset:30816
    v_pk_max_i16 v117, v117, 0
    v_mfma_f32_16x16x32_bf16 v[156:159], a[156:159], a[52:55], v[156:159]
    ds_read_b64_tr_b16 a[198:199], v37 offset:32096
    v_pk_max_i16 v118, v118, 0
    v_mfma_f32_16x16x32_bf16 v[160:163], a[160:163], a[48:51], v[160:163]
    ds_read_b64_tr_b16 a[200:201], v36 offset:30848
    v_pk_max_i16 v119, v119, 0
    v_mfma_f32_16x16x32_bf16 v[164:167], a[160:163], a[52:55], v[164:167]
    ds_read_b64_tr_b16 a[202:203], v36 offset:32128
    buffer_store_dwordx4 v[116:119], v47, s[16:19], s42 offen offset:1024 sc1
    s_waitcnt lgkmcnt(10)
    v_mfma_f32_16x16x32_bf16 v[168:171], a[164:167], a[48:51], v[168:171]
    ds_read_b64_tr_b16 a[204:205], v37 offset:30880
    v_mfma_f32_16x16x32_bf16 v[172:175], a[164:167], a[52:55], v[172:175]
    ds_read_b64_tr_b16 a[206:207], v37 offset:32160
    v_mfma_f32_16x16x32_bf16 v[176:179], a[168:171], a[48:51], v[176:179]
    ds_read_b64_tr_b16 a[208:209], v36 offset:30912
    v_mfma_f32_16x16x32_bf16 v[180:183], a[168:171], a[52:55], v[180:183]
    ds_read_b64_tr_b16 a[210:211], v36 offset:32192
    v_mfma_f32_16x16x32_bf16 v[184:187], a[172:175], a[48:51], v[184:187]
    ds_read_b64_tr_b16 a[212:213], v37 offset:30944
    buffer_load_dword v255, v53, s[20:23], s100 offen
    v_mfma_f32_16x16x32_bf16 v[188:191], a[172:175], a[52:55], v[188:191]
    ds_read_b64_tr_b16 a[214:215], v37 offset:32224
    v_mfma_f32_16x16x32_bf16 v[192:195], a[176:179], a[48:51], v[192:195]
    ds_read_b64_tr_b16 a[216:217], v36 offset:30976
    v_mfma_f32_16x16x32_bf16 v[196:199], a[176:179], a[52:55], v[196:199]
    ds_read_b64_tr_b16 a[218:219], v36 offset:32256
    v_mfma_f32_16x16x32_bf16 v[200:203], a[180:183], a[48:51], v[200:203]
    ds_read_b64_tr_b16 a[220:221], v37 offset:31008
    v_mfma_f32_16x16x32_bf16 v[204:207], a[180:183], a[52:55], v[204:207]
    ds_read_b64_tr_b16 a[222:223], v37 offset:32288
    s_waitcnt lgkmcnt(10)
    s_waitcnt vmcnt(29)
    v_mfma_f32_16x16x32_bf16 v[128:131], a[184:187], a[56:59], v[128:131]
    s_barrier
    ds_read_b64_tr_b16 a[144:145], v40 offset:0
    v_mfma_f32_16x16x32_bf16 v[132:135], a[184:187], a[60:63], v[132:135]
    ds_read_b64_tr_b16 a[146:147], v40 offset:1280
    v_mfma_f32_16x16x32_bf16 v[136:139], a[188:191], a[56:59], v[136:139]
    ds_read_b64_tr_b16 a[148:149], v41 offset:32
    v_mfma_f32_16x16x32_bf16 v[140:143], a[188:191], a[60:63], v[140:143]
    ds_read_b64_tr_b16 a[150:151], v41 offset:1312
    buffer_load_dword v255, v54, s[20:23], s100 offen
    v_mfma_f32_16x16x32_bf16 v[144:147], a[192:195], a[56:59], v[144:147]
    ds_read_b64_tr_b16 a[152:153], v40 offset:64
    v_mfma_f32_16x16x32_bf16 v[148:151], a[192:195], a[60:63], v[148:151]
    ds_read_b64_tr_b16 a[154:155], v40 offset:1344
    v_mfma_f32_16x16x32_bf16 v[152:155], a[196:199], a[56:59], v[152:155]
    ds_read_b64_tr_b16 a[156:157], v41 offset:96
    v_mfma_f32_16x16x32_bf16 v[156:159], a[196:199], a[60:63], v[156:159]
    ds_read_b64_tr_b16 a[158:159], v41 offset:1376
    v_mfma_f32_16x16x32_bf16 v[160:163], a[200:203], a[56:59], v[160:163]
    ds_read_b64_tr_b16 a[160:161], v40 offset:128
    v_mfma_f32_16x16x32_bf16 v[164:167], a[200:203], a[60:63], v[164:167]
    ds_read_b64_tr_b16 a[162:163], v40 offset:1408
    s_waitcnt lgkmcnt(10)
    v_mfma_f32_16x16x32_bf16 v[168:171], a[204:207], a[56:59], v[168:171]
    ds_read_b64_tr_b16 a[164:165], v41 offset:160
    v_mfma_f32_16x16x32_bf16 v[172:175], a[204:207], a[60:63], v[172:175]
    ds_read_b64_tr_b16 a[166:167], v41 offset:1440
    v_mfma_f32_16x16x32_bf16 v[176:179], a[208:211], a[56:59], v[176:179]
    ds_read_b64_tr_b16 a[168:169], v40 offset:192
    v_mfma_f32_16x16x32_bf16 v[180:183], a[208:211], a[60:63], v[180:183]
    ds_read_b64_tr_b16 a[170:171], v40 offset:1472
    v_mfma_f32_16x16x32_bf16 v[184:187], a[212:215], a[56:59], v[184:187]
    ds_read_b64_tr_b16 a[172:173], v41 offset:224
    v_mfma_f32_16x16x32_bf16 v[188:191], a[212:215], a[60:63], v[188:191]
    ds_read_b64_tr_b16 a[174:175], v41 offset:1504
    v_mfma_f32_16x16x32_bf16 v[192:195], a[216:219], a[56:59], v[192:195]
    ds_read_b64_tr_b16 a[176:177], v40 offset:256
    v_mfma_f32_16x16x32_bf16 v[196:199], a[216:219], a[60:63], v[196:199]
    ds_read_b64_tr_b16 a[178:179], v40 offset:1536
    v_mfma_f32_16x16x32_bf16 v[200:203], a[220:223], a[56:59], v[200:203]
    ds_read_b64_tr_b16 a[180:181], v41 offset:288
    v_mfma_f32_16x16x32_bf16 v[204:207], a[220:223], a[60:63], v[204:207]
    ds_read_b64_tr_b16 a[182:183], v41 offset:1568
    s_waitcnt lgkmcnt(10)
    v_mfma_f32_16x16x32_bf16 v[128:131], a[144:147], a[64:67], v[128:131]
    ds_read_b64_tr_b16 a[184:185], v40 offset:10240
    v_mfma_f32_16x16x32_bf16 v[132:135], a[144:147], a[68:71], v[132:135]
    ds_read_b64_tr_b16 a[186:187], v40 offset:11520
    v_mfma_f32_16x16x32_bf16 v[136:139], a[148:151], a[64:67], v[136:139]
    ds_read_b64_tr_b16 a[188:189], v41 offset:10272
    v_mfma_f32_16x16x32_bf16 v[140:143], a[148:151], a[68:71], v[140:143]
    ds_read_b64_tr_b16 a[190:191], v41 offset:11552
    v_mfma_f32_16x16x32_bf16 v[144:147], a[152:155], a[64:67], v[144:147]
    ds_read_b64_tr_b16 a[192:193], v40 offset:10304
    v_mfma_f32_16x16x32_bf16 v[148:151], a[152:155], a[68:71], v[148:151]
    ds_read_b64_tr_b16 a[194:195], v40 offset:11584
    v_mfma_f32_16x16x32_bf16 v[152:155], a[156:159], a[64:67], v[152:155]
    ds_read_b64_tr_b16 a[196:197], v41 offset:10336
    v_mfma_f32_16x16x32_bf16 v[156:159], a[156:159], a[68:71], v[156:159]
    ds_read_b64_tr_b16 a[198:199], v41 offset:11616
    v_mfma_f32_16x16x32_bf16 v[160:163], a[160:163], a[64:67], v[160:163]
    ds_read_b64_tr_b16 a[200:201], v40 offset:10368
    v_mfma_f32_16x16x32_bf16 v[164:167], a[160:163], a[68:71], v[164:167]
    ds_read_b64_tr_b16 a[202:203], v40 offset:11648
    s_waitcnt lgkmcnt(10)
    v_mfma_f32_16x16x32_bf16 v[168:171], a[164:167], a[64:67], v[168:171]
    ds_read_b64_tr_b16 a[204:205], v41 offset:10400
    v_mfma_f32_16x16x32_bf16 v[172:175], a[164:167], a[68:71], v[172:175]
    ds_read_b64_tr_b16 a[206:207], v41 offset:11680
    v_mfma_f32_16x16x32_bf16 v[176:179], a[168:171], a[64:67], v[176:179]
    ds_read_b64_tr_b16 a[208:209], v40 offset:10432
    v_mfma_f32_16x16x32_bf16 v[180:183], a[168:171], a[68:71], v[180:183]
    ds_read_b64_tr_b16 a[210:211], v40 offset:11712
    v_mfma_f32_16x16x32_bf16 v[184:187], a[172:175], a[64:67], v[184:187]
    ds_read_b64_tr_b16 a[212:213], v41 offset:10464
    v_mfma_f32_16x16x32_bf16 v[188:191], a[172:175], a[68:71], v[188:191]
    ds_read_b64_tr_b16 a[214:215], v41 offset:11744
    v_mfma_f32_16x16x32_bf16 v[192:195], a[176:179], a[64:67], v[192:195]
    ds_read_b64_tr_b16 a[216:217], v40 offset:10496
    v_mfma_f32_16x16x32_bf16 v[196:199], a[176:179], a[68:71], v[196:199]
    ds_read_b64_tr_b16 a[218:219], v40 offset:11776
    v_mfma_f32_16x16x32_bf16 v[200:203], a[180:183], a[64:67], v[200:203]
    ds_read_b64_tr_b16 a[220:221], v41 offset:10528
    v_mfma_f32_16x16x32_bf16 v[204:207], a[180:183], a[68:71], v[204:207]
    ds_read_b64_tr_b16 a[222:223], v41 offset:11808
    s_waitcnt lgkmcnt(10)
    s_waitcnt vmcnt(24)
    v_mfma_f32_16x16x32_bf16 v[128:131], a[184:187], a[72:75], v[128:131]
    s_barrier
    ds_read_b64_tr_b16 a[144:145], v36 offset:40960
    v_mfma_f32_16x16x32_bf16 v[132:135], a[184:187], a[76:79], v[132:135]
    ds_read_b64_tr_b16 a[146:147], v36 offset:42240
    v_mfma_f32_16x16x32_bf16 v[136:139], a[188:191], a[72:75], v[136:139]
    ds_read_b64_tr_b16 a[148:149], v37 offset:40992
    v_mfma_f32_16x16x32_bf16 v[140:143], a[188:191], a[76:79], v[140:143]
    ds_read_b64_tr_b16 a[150:151], v37 offset:42272
    v_mfma_f32_16x16x32_bf16 v[144:147], a[192:195], a[72:75], v[144:147]
    ds_read_b64_tr_b16 a[152:153], v36 offset:41024
    v_mfma_f32_16x16x32_bf16 v[148:151], a[192:195], a[76:79], v[148:151]
    ds_read_b64_tr_b16 a[154:155], v36 offset:42304
    v_mfma_f32_16x16x32_bf16 v[152:155], a[196:199], a[72:75], v[152:155]
    ds_read_b64_tr_b16 a[156:157], v37 offset:41056
    v_mfma_f32_16x16x32_bf16 v[156:159], a[196:199], a[76:79], v[156:159]
    ds_read_b64_tr_b16 a[158:159], v37 offset:42336
    v_mfma_f32_16x16x32_bf16 v[160:163], a[200:203], a[72:75], v[160:163]
    ds_read_b64_tr_b16 a[160:161], v36 offset:41088
    v_mfma_f32_16x16x32_bf16 v[164:167], a[200:203], a[76:79], v[164:167]
    ds_read_b64_tr_b16 a[162:163], v36 offset:42368
    s_waitcnt lgkmcnt(10)
    v_mfma_f32_16x16x32_bf16 v[168:171], a[204:207], a[72:75], v[168:171]
    ds_read_b64_tr_b16 a[164:165], v37 offset:41120
    v_mfma_f32_16x16x32_bf16 v[172:175], a[204:207], a[76:79], v[172:175]
    ds_read_b64_tr_b16 a[166:167], v37 offset:42400
    v_mfma_f32_16x16x32_bf16 v[176:179], a[208:211], a[72:75], v[176:179]
    ds_read_b64_tr_b16 a[168:169], v36 offset:41152
    v_mfma_f32_16x16x32_bf16 v[180:183], a[208:211], a[76:79], v[180:183]
    ds_read_b64_tr_b16 a[170:171], v36 offset:42432
    v_mfma_f32_16x16x32_bf16 v[184:187], a[212:215], a[72:75], v[184:187]
    ds_read_b64_tr_b16 a[172:173], v37 offset:41184
    v_mfma_f32_16x16x32_bf16 v[188:191], a[212:215], a[76:79], v[188:191]
    ds_read_b64_tr_b16 a[174:175], v37 offset:42464
    v_mfma_f32_16x16x32_bf16 v[192:195], a[216:219], a[72:75], v[192:195]
    ds_read_b64_tr_b16 a[176:177], v36 offset:41216
    v_mfma_f32_16x16x32_bf16 v[196:199], a[216:219], a[76:79], v[196:199]
    ds_read_b64_tr_b16 a[178:179], v36 offset:42496
    v_mfma_f32_16x16x32_bf16 v[200:203], a[220:223], a[72:75], v[200:203]
    ds_read_b64_tr_b16 a[180:181], v37 offset:41248
    v_mfma_f32_16x16x32_bf16 v[204:207], a[220:223], a[76:79], v[204:207]
    ds_read_b64_tr_b16 a[182:183], v37 offset:42528
    s_waitcnt lgkmcnt(10)
    v_mfma_f32_16x16x32_bf16 v[128:131], a[144:147], a[80:83], v[128:131]
    ds_read_b64_tr_b16 a[184:185], v36 offset:51200
    v_mfma_f32_16x16x32_bf16 v[132:135], a[144:147], a[84:87], v[132:135]
    ds_read_b64_tr_b16 a[186:187], v36 offset:52480
    v_mfma_f32_16x16x32_bf16 v[136:139], a[148:151], a[80:83], v[136:139]
    ds_read_b64_tr_b16 a[188:189], v37 offset:51232
    v_mfma_f32_16x16x32_bf16 v[140:143], a[148:151], a[84:87], v[140:143]
    ds_read_b64_tr_b16 a[190:191], v37 offset:52512
    v_mfma_f32_16x16x32_bf16 v[144:147], a[152:155], a[80:83], v[144:147]
    ds_read_b64_tr_b16 a[192:193], v36 offset:51264
    v_mfma_f32_16x16x32_bf16 v[148:151], a[152:155], a[84:87], v[148:151]
    ds_read_b64_tr_b16 a[194:195], v36 offset:52544
    v_mfma_f32_16x16x32_bf16 v[152:155], a[156:159], a[80:83], v[152:155]
    ds_read_b64_tr_b16 a[196:197], v37 offset:51296
    v_mfma_f32_16x16x32_bf16 v[156:159], a[156:159], a[84:87], v[156:159]
    ds_read_b64_tr_b16 a[198:199], v37 offset:52576
    v_mfma_f32_16x16x32_bf16 v[160:163], a[160:163], a[80:83], v[160:163]
    ds_read_b64_tr_b16 a[200:201], v36 offset:51328
    v_mfma_f32_16x16x32_bf16 v[164:167], a[160:163], a[84:87], v[164:167]
    ds_read_b64_tr_b16 a[202:203], v36 offset:52608
    s_waitcnt lgkmcnt(10)
    v_mfma_f32_16x16x32_bf16 v[168:171], a[164:167], a[80:83], v[168:171]
    ds_read_b64_tr_b16 a[204:205], v37 offset:51360
    v_mfma_f32_16x16x32_bf16 v[172:175], a[164:167], a[84:87], v[172:175]
    ds_read_b64_tr_b16 a[206:207], v37 offset:52640
    v_mfma_f32_16x16x32_bf16 v[176:179], a[168:171], a[80:83], v[176:179]
    ds_read_b64_tr_b16 a[208:209], v36 offset:51392
    v_mfma_f32_16x16x32_bf16 v[180:183], a[168:171], a[84:87], v[180:183]
    ds_read_b64_tr_b16 a[210:211], v36 offset:52672
    v_mfma_f32_16x16x32_bf16 v[184:187], a[172:175], a[80:83], v[184:187]
    ds_read_b64_tr_b16 a[212:213], v37 offset:51424
    v_mfma_f32_16x16x32_bf16 v[188:191], a[172:175], a[84:87], v[188:191]
    ds_read_b64_tr_b16 a[214:215], v37 offset:52704
    v_mfma_f32_16x16x32_bf16 v[192:195], a[176:179], a[80:83], v[192:195]
    ds_read_b64_tr_b16 a[216:217], v36 offset:51456
    v_mfma_f32_16x16x32_bf16 v[196:199], a[176:179], a[84:87], v[196:199]
    ds_read_b64_tr_b16 a[218:219], v36 offset:52736
    v_mfma_f32_16x16x32_bf16 v[200:203], a[180:183], a[80:83], v[200:203]
    ds_read_b64_tr_b16 a[220:221], v37 offset:51488
    v_mfma_f32_16x16x32_bf16 v[204:207], a[180:183], a[84:87], v[204:207]
    ds_read_b64_tr_b16 a[222:223], v37 offset:52768
    s_waitcnt lgkmcnt(10)
    s_waitcnt vmcnt(17)
    v_mfma_f32_16x16x32_bf16 v[128:131], a[184:187], a[88:91], v[128:131]
    s_barrier
    ds_read_b64_tr_b16 a[144:145], v40 offset:20480
    v_mfma_f32_16x16x32_bf16 v[132:135], a[184:187], a[92:95], v[132:135]
    ds_read_b64_tr_b16 a[146:147], v40 offset:21760
    v_mfma_f32_16x16x32_bf16 v[136:139], a[188:191], a[88:91], v[136:139]
    ds_read_b64_tr_b16 a[148:149], v41 offset:20512
    v_mfma_f32_16x16x32_bf16 v[140:143], a[188:191], a[92:95], v[140:143]
    ds_read_b64_tr_b16 a[150:151], v41 offset:21792
    v_mfma_f32_16x16x32_bf16 v[144:147], a[192:195], a[88:91], v[144:147]
    ds_read_b64_tr_b16 a[152:153], v40 offset:20544
    v_mfma_f32_16x16x32_bf16 v[148:151], a[192:195], a[92:95], v[148:151]
    ds_read_b64_tr_b16 a[154:155], v40 offset:21824
    v_mfma_f32_16x16x32_bf16 v[152:155], a[196:199], a[88:91], v[152:155]
    ds_read_b64_tr_b16 a[156:157], v41 offset:20576
    v_mfma_f32_16x16x32_bf16 v[156:159], a[196:199], a[92:95], v[156:159]
    ds_read_b64_tr_b16 a[158:159], v41 offset:21856
    v_mfma_f32_16x16x32_bf16 v[160:163], a[200:203], a[88:91], v[160:163]
    ds_read_b64_tr_b16 a[160:161], v40 offset:20608
    v_mfma_f32_16x16x32_bf16 v[164:167], a[200:203], a[92:95], v[164:167]
    ds_read_b64_tr_b16 a[162:163], v40 offset:21888
    s_waitcnt lgkmcnt(10)
    v_mfma_f32_16x16x32_bf16 v[168:171], a[204:207], a[88:91], v[168:171]
    ds_read_b64_tr_b16 a[164:165], v41 offset:20640
    v_mfma_f32_16x16x32_bf16 v[172:175], a[204:207], a[92:95], v[172:175]
    ds_read_b64_tr_b16 a[166:167], v41 offset:21920
    v_mfma_f32_16x16x32_bf16 v[176:179], a[208:211], a[88:91], v[176:179]
    ds_read_b64_tr_b16 a[168:169], v40 offset:20672
    v_mfma_f32_16x16x32_bf16 v[180:183], a[208:211], a[92:95], v[180:183]
    ds_read_b64_tr_b16 a[170:171], v40 offset:21952
    v_mfma_f32_16x16x32_bf16 v[184:187], a[212:215], a[88:91], v[184:187]
    ds_read_b64_tr_b16 a[172:173], v41 offset:20704
    v_mfma_f32_16x16x32_bf16 v[188:191], a[212:215], a[92:95], v[188:191]
    ds_read_b64_tr_b16 a[174:175], v41 offset:21984
    v_mfma_f32_16x16x32_bf16 v[192:195], a[216:219], a[88:91], v[192:195]
    ds_read_b64_tr_b16 a[176:177], v40 offset:20736
    v_mfma_f32_16x16x32_bf16 v[196:199], a[216:219], a[92:95], v[196:199]
    ds_read_b64_tr_b16 a[178:179], v40 offset:22016
    v_mfma_f32_16x16x32_bf16 v[200:203], a[220:223], a[88:91], v[200:203]
    ds_read_b64_tr_b16 a[180:181], v41 offset:20768
    v_mfma_f32_16x16x32_bf16 v[204:207], a[220:223], a[92:95], v[204:207]
    ds_read_b64_tr_b16 a[182:183], v41 offset:22048
    s_waitcnt lgkmcnt(10)
    v_mfma_f32_16x16x32_bf16 v[128:131], a[144:147], a[96:99], v[128:131]
    ds_read_b64_tr_b16 a[184:185], v40 offset:30720
    v_mfma_f32_16x16x32_bf16 v[132:135], a[144:147], a[100:103], v[132:135]
    ds_read_b64_tr_b16 a[186:187], v40 offset:32000
    v_mfma_f32_16x16x32_bf16 v[136:139], a[148:151], a[96:99], v[136:139]
    ds_read_b64_tr_b16 a[188:189], v41 offset:30752
    v_mfma_f32_16x16x32_bf16 v[140:143], a[148:151], a[100:103], v[140:143]
    ds_read_b64_tr_b16 a[190:191], v41 offset:32032
    v_mfma_f32_16x16x32_bf16 v[144:147], a[152:155], a[96:99], v[144:147]
    ds_read_b64_tr_b16 a[192:193], v40 offset:30784
    v_mfma_f32_16x16x32_bf16 v[148:151], a[152:155], a[100:103], v[148:151]
    ds_read_b64_tr_b16 a[194:195], v40 offset:32064
    v_mfma_f32_16x16x32_bf16 v[152:155], a[156:159], a[96:99], v[152:155]
    ds_read_b64_tr_b16 a[196:197], v41 offset:30816
    v_mfma_f32_16x16x32_bf16 v[156:159], a[156:159], a[100:103], v[156:159]
    ds_read_b64_tr_b16 a[198:199], v41 offset:32096
    v_mfma_f32_16x16x32_bf16 v[160:163], a[160:163], a[96:99], v[160:163]
    ds_read_b64_tr_b16 a[200:201], v40 offset:30848
    v_mfma_f32_16x16x32_bf16 v[164:167], a[160:163], a[100:103], v[164:167]
    ds_read_b64_tr_b16 a[202:203], v40 offset:32128
    s_waitcnt lgkmcnt(10)
    v_mfma_f32_16x16x32_bf16 v[168:171], a[164:167], a[96:99], v[168:171]
    ds_read_b64_tr_b16 a[204:205], v41 offset:30880
    v_mfma_f32_16x16x32_bf16 v[172:175], a[164:167], a[100:103], v[172:175]
    ds_read_b64_tr_b16 a[206:207], v41 offset:32160
    v_mfma_f32_16x16x32_bf16 v[176:179], a[168:171], a[96:99], v[176:179]
    ds_read_b64_tr_b16 a[208:209], v40 offset:30912
    v_mfma_f32_16x16x32_bf16 v[180:183], a[168:171], a[100:103], v[180:183]
    ds_read_b64_tr_b16 a[210:211], v40 offset:32192
    v_mfma_f32_16x16x32_bf16 v[184:187], a[172:175], a[96:99], v[184:187]
    ds_read_b64_tr_b16 a[212:213], v41 offset:30944
    v_mfma_f32_16x16x32_bf16 v[188:191], a[172:175], a[100:103], v[188:191]
    ds_read_b64_tr_b16 a[214:215], v41 offset:32224
    v_mfma_f32_16x16x32_bf16 v[192:195], a[176:179], a[96:99], v[192:195]
    ds_read_b64_tr_b16 a[216:217], v40 offset:30976
    v_mfma_f32_16x16x32_bf16 v[196:199], a[176:179], a[100:103], v[196:199]
    ds_read_b64_tr_b16 a[218:219], v40 offset:32256
    v_mfma_f32_16x16x32_bf16 v[200:203], a[180:183], a[96:99], v[200:203]
    ds_read_b64_tr_b16 a[220:221], v41 offset:31008
    v_mfma_f32_16x16x32_bf16 v[204:207], a[180:183], a[100:103], v[204:207]
    ds_read_b64_tr_b16 a[222:223], v41 offset:32288
    s_waitcnt lgkmcnt(10)
    s_waitcnt vmcnt(10)
    v_mfma_f32_16x16x32_bf16 v[128:131], a[184:187], a[104:107], v[128:131]
    s_barrier
    ds_read_b64_tr_b16 a[144:145], v38 offset:0
    v_mfma_f32_16x16x32_bf16 v[132:135], a[184:187], a[108:111], v[132:135]
    ds_read_b64_tr_b16 a[146:147], v38 offset:1280
    v_mfma_f32_16x16x32_bf16 v[136:139], a[188:191], a[104:107], v[136:139]
    ds_read_b64_tr_b16 a[148:149], v39 offset:32
    v_mfma_f32_16x16x32_bf16 v[140:143], a[188:191], a[108:111], v[140:143]
    ds_read_b64_tr_b16 a[150:151], v39 offset:1312
    v_mfma_f32_16x16x32_bf16 v[144:147], a[192:195], a[104:107], v[144:147]
    ds_read_b64_tr_b16 a[152:153], v38 offset:64
    v_mfma_f32_16x16x32_bf16 v[148:151], a[192:195], a[108:111], v[148:151]
    ds_read_b64_tr_b16 a[154:155], v38 offset:1344
    v_mfma_f32_16x16x32_bf16 v[152:155], a[196:199], a[104:107], v[152:155]
    ds_read_b64_tr_b16 a[156:157], v39 offset:96
    v_mfma_f32_16x16x32_bf16 v[156:159], a[196:199], a[108:111], v[156:159]
    ds_read_b64_tr_b16 a[158:159], v39 offset:1376
    v_mfma_f32_16x16x32_bf16 v[160:163], a[200:203], a[104:107], v[160:163]
    ds_read_b64_tr_b16 a[160:161], v38 offset:128
    v_mfma_f32_16x16x32_bf16 v[164:167], a[200:203], a[108:111], v[164:167]
    ds_read_b64_tr_b16 a[162:163], v38 offset:1408
    s_waitcnt lgkmcnt(10)
    v_mfma_f32_16x16x32_bf16 v[168:171], a[204:207], a[104:107], v[168:171]
    ds_read_b64_tr_b16 a[164:165], v39 offset:160
    v_mfma_f32_16x16x32_bf16 v[172:175], a[204:207], a[108:111], v[172:175]
    ds_read_b64_tr_b16 a[166:167], v39 offset:1440
    v_mfma_f32_16x16x32_bf16 v[176:179], a[208:211], a[104:107], v[176:179]
    ds_read_b64_tr_b16 a[168:169], v38 offset:192
    v_mfma_f32_16x16x32_bf16 v[180:183], a[208:211], a[108:111], v[180:183]
    ds_read_b64_tr_b16 a[170:171], v38 offset:1472
    s_add_u32 m0, s38, 0
    v_mfma_f32_16x16x32_bf16 v[184:187], a[212:215], a[104:107], v[184:187]
    ds_read_b64_tr_b16 a[172:173], v39 offset:224
    buffer_load_dwordx4 v15, s[20:23], s62 offen offset:0 lds
    v_mfma_f32_16x16x32_bf16 v[188:191], a[212:215], a[108:111], v[188:191]
    ds_read_b64_tr_b16 a[174:175], v39 offset:1504
    v_mfma_f32_16x16x32_bf16 v[192:195], a[216:219], a[104:107], v[192:195]
    ds_read_b64_tr_b16 a[176:177], v38 offset:256
    v_mfma_f32_16x16x32_bf16 v[196:199], a[216:219], a[108:111], v[196:199]
    ds_read_b64_tr_b16 a[178:179], v38 offset:1536
    buffer_load_dwordx4 v16, s[20:23], s62 offen offset:1024 lds
    v_mfma_f32_16x16x32_bf16 v[200:203], a[220:223], a[104:107], v[200:203]
    ds_read_b64_tr_b16 a[180:181], v39 offset:288
    v_mfma_f32_16x16x32_bf16 v[204:207], a[220:223], a[108:111], v[204:207]
    ds_read_b64_tr_b16 a[182:183], v39 offset:1568
    s_waitcnt lgkmcnt(10)
    v_mfma_f32_16x16x32_bf16 v[128:131], a[144:147], a[112:115], v[128:131]
    ds_read_b64_tr_b16 a[184:185], v38 offset:10240
    buffer_load_dwordx4 v17, s[20:23], s62 offen offset:2048 lds
    v_mfma_f32_16x16x32_bf16 v[132:135], a[144:147], a[116:119], v[132:135]
    ds_read_b64_tr_b16 a[186:187], v38 offset:11520
    v_mfma_f32_16x16x32_bf16 v[136:139], a[148:151], a[112:115], v[136:139]
    ds_read_b64_tr_b16 a[188:189], v39 offset:10272
    v_mfma_f32_16x16x32_bf16 v[140:143], a[148:151], a[116:119], v[140:143]
    ds_read_b64_tr_b16 a[190:191], v39 offset:11552
    v_mfma_f32_16x16x32_bf16 v[144:147], a[152:155], a[112:115], v[144:147]
    ds_read_b64_tr_b16 a[192:193], v38 offset:10304
    buffer_load_dwordx4 v18, s[20:23], s62 offen offset:3072 lds
    s_add_u32 m0, s38, 4096
    v_mfma_f32_16x16x32_bf16 v[148:151], a[152:155], a[116:119], v[148:151]
    ds_read_b64_tr_b16 a[194:195], v38 offset:11584
    v_mfma_f32_16x16x32_bf16 v[152:155], a[156:159], a[112:115], v[152:155]
    ds_read_b64_tr_b16 a[196:197], v39 offset:10336
    v_mfma_f32_16x16x32_bf16 v[156:159], a[156:159], a[116:119], v[156:159]
    ds_read_b64_tr_b16 a[198:199], v39 offset:11616
    buffer_load_dwordx4 v19, s[20:23], s62 offen lds
    s_add_u32 m0, s38, 102400
    v_mfma_f32_16x16x32_bf16 v[160:163], a[160:163], a[112:115], v[160:163]
    ds_read_b64_tr_b16 a[200:201], v38 offset:10368
    v_mfma_f32_16x16x32_bf16 v[164:167], a[160:163], a[116:119], v[164:167]
    ds_read_b64_tr_b16 a[202:203], v38 offset:11648
    s_waitcnt lgkmcnt(10)
    v_mfma_f32_16x16x32_bf16 v[168:171], a[164:167], a[112:115], v[168:171]
    ds_read_b64_tr_b16 a[204:205], v39 offset:10400
    v_mfma_f32_16x16x32_bf16 v[172:175], a[164:167], a[116:119], v[172:175]
    ds_read_b64_tr_b16 a[206:207], v39 offset:11680
    buffer_load_dwordx4 v15, s[20:23], s63 offen offset:0 lds
    v_mfma_f32_16x16x32_bf16 v[176:179], a[168:171], a[112:115], v[176:179]
    ds_read_b64_tr_b16 a[208:209], v38 offset:10432
    v_mfma_f32_16x16x32_bf16 v[180:183], a[168:171], a[116:119], v[180:183]
    ds_read_b64_tr_b16 a[210:211], v38 offset:11712
    v_mfma_f32_16x16x32_bf16 v[184:187], a[172:175], a[112:115], v[184:187]
    ds_read_b64_tr_b16 a[212:213], v39 offset:10464
    buffer_load_dwordx4 v16, s[20:23], s63 offen offset:1024 lds
    v_mfma_f32_16x16x32_bf16 v[188:191], a[172:175], a[116:119], v[188:191]
    ds_read_b64_tr_b16 a[214:215], v39 offset:11744
    v_mfma_f32_16x16x32_bf16 v[192:195], a[176:179], a[112:115], v[192:195]
    ds_read_b64_tr_b16 a[216:217], v38 offset:10496
    v_mfma_f32_16x16x32_bf16 v[196:199], a[176:179], a[116:119], v[196:199]
    ds_read_b64_tr_b16 a[218:219], v38 offset:11776
    v_mfma_f32_16x16x32_bf16 v[200:203], a[180:183], a[112:115], v[200:203]
    ds_read_b64_tr_b16 a[220:221], v39 offset:10528
    buffer_load_dwordx4 v17, s[20:23], s63 offen offset:2048 lds
    v_mfma_f32_16x16x32_bf16 v[204:207], a[180:183], a[116:119], v[204:207]
    ds_read_b64_tr_b16 a[222:223], v39 offset:11808
    s_waitcnt lgkmcnt(10)
    s_waitcnt vmcnt(10)
    v_mfma_f32_16x16x32_bf16 v[128:131], a[184:187], a[120:123], v[128:131]
    s_barrier
    ds_read_b64_tr_b16 a[144:145], v38 offset:20480
    v_mfma_f32_16x16x32_bf16 v[132:135], a[184:187], a[124:127], v[132:135]
    ds_read_b64_tr_b16 a[146:147], v38 offset:21760
    buffer_load_dwordx4 v18, s[20:23], s63 offen offset:3072 lds
    s_add_u32 m0, s38, 106496
    v_mfma_f32_16x16x32_bf16 v[136:139], a[188:191], a[120:123], v[136:139]
    ds_read_b64_tr_b16 a[148:149], v39 offset:20512
    v_mfma_f32_16x16x32_bf16 v[140:143], a[188:191], a[124:127], v[140:143]
    ds_read_b64_tr_b16 a[150:151], v39 offset:21792
    v_mfma_f32_16x16x32_bf16 v[144:147], a[192:195], a[120:123], v[144:147]
    ds_read_b64_tr_b16 a[152:153], v38 offset:20544
    v_mfma_f32_16x16x32_bf16 v[148:151], a[192:195], a[124:127], v[148:151]
    ds_read_b64_tr_b16 a[154:155], v38 offset:21824
    buffer_store_dword v52, v50, s[16:19], 0 offen offset:0 sc1
    v_mfma_f32_16x16x32_bf16 v[152:155], a[196:199], a[120:123], v[152:155]
    ds_read_b64_tr_b16 a[156:157], v39 offset:20576
    buffer_load_dwordx4 v19, s[20:23], s63 offen lds
    s_add_u32 m0, s38, 20480
    v_mfma_f32_16x16x32_bf16 v[156:159], a[196:199], a[124:127], v[156:159]
    ds_read_b64_tr_b16 a[158:159], v39 offset:21856
    v_mfma_f32_16x16x32_bf16 v[160:163], a[200:203], a[120:123], v[160:163]
    ds_read_b64_tr_b16 a[160:161], v38 offset:20608
    v_mfma_f32_16x16x32_bf16 v[164:167], a[200:203], a[124:127], v[164:167]
    ds_read_b64_tr_b16 a[162:163], v38 offset:21888
    buffer_load_dwordx4 v15, s[20:23], s64 offen offset:0 lds
    s_waitcnt lgkmcnt(10)
    v_mfma_f32_16x16x32_bf16 v[168:171], a[204:207], a[120:123], v[168:171]
    ds_read_b64_tr_b16 a[164:165], v39 offset:20640
    v_mfma_f32_16x16x32_bf16 v[172:175], a[204:207], a[124:127], v[172:175]
    ds_read_b64_tr_b16 a[166:167], v39 offset:21920
    v_mfma_f32_16x16x32_bf16 v[176:179], a[208:211], a[120:123], v[176:179]
    ds_read_b64_tr_b16 a[168:169], v38 offset:20672
    buffer_load_dwordx4 v16, s[20:23], s64 offen offset:1024 lds
    v_mfma_f32_16x16x32_bf16 v[180:183], a[208:211], a[124:127], v[180:183]
    ds_read_b64_tr_b16 a[170:171], v38 offset:21952
    v_mfma_f32_16x16x32_bf16 v[184:187], a[212:215], a[120:123], v[184:187]
    ds_read_b64_tr_b16 a[172:173], v39 offset:20704
    v_mfma_f32_16x16x32_bf16 v[188:191], a[212:215], a[124:127], v[188:191]
    ds_read_b64_tr_b16 a[174:175], v39 offset:21984
    v_mfma_f32_16x16x32_bf16 v[192:195], a[216:219], a[120:123], v[192:195]
    ds_read_b64_tr_b16 a[176:177], v38 offset:20736
    buffer_load_dwordx4 v17, s[20:23], s64 offen offset:2048 lds
    v_mfma_f32_16x16x32_bf16 v[196:199], a[216:219], a[124:127], v[196:199]
    ds_read_b64_tr_b16 a[178:179], v38 offset:22016
    v_mfma_f32_16x16x32_bf16 v[200:203], a[220:223], a[120:123], v[200:203]
    ds_read_b64_tr_b16 a[180:181], v39 offset:20768
    v_mfma_f32_16x16x32_bf16 v[204:207], a[220:223], a[124:127], v[204:207]
    ds_read_b64_tr_b16 a[182:183], v39 offset:22048
    buffer_load_dwordx4 v18, s[20:23], s64 offen offset:3072 lds
    s_add_u32 m0, s38, 24576
    s_waitcnt lgkmcnt(10)
    v_mfma_f32_16x16x32_bf16 v[128:131], a[144:147], a[128:131], v[128:131]
    ds_read_b64_tr_b16 a[184:185], v38 offset:30720
    v_mfma_f32_16x16x32_bf16 v[132:135], a[144:147], a[132:135], v[132:135]
    ds_read_b64_tr_b16 a[186:187], v38 offset:32000
    v_mfma_f32_16x16x32_bf16 v[136:139], a[148:151], a[128:131], v[136:139]
    ds_read_b64_tr_b16 a[188:189], v39 offset:30752
    v_mfma_f32_16x16x32_bf16 v[140:143], a[148:151], a[132:135], v[140:143]
    ds_read_b64_tr_b16 a[190:191], v39 offset:32032
    buffer_load_dwordx4 v19, s[20:23], s64 offen lds
    s_add_u32 m0, s38, 122880
    v_mfma_f32_16x16x32_bf16 v[144:147], a[152:155], a[128:131], v[144:147]
    ds_read_b64_tr_b16 a[192:193], v38 offset:30784
    v_mfma_f32_16x16x32_bf16 v[148:151], a[152:155], a[132:135], v[148:151]
    ds_read_b64_tr_b16 a[194:195], v38 offset:32064
    v_mfma_f32_16x16x32_bf16 v[152:155], a[156:159], a[128:131], v[152:155]
    ds_read_b64_tr_b16 a[196:197], v39 offset:30816
    buffer_load_dwordx4 v15, s[20:23], s65 offen offset:0 lds
    v_mfma_f32_16x16x32_bf16 v[156:159], a[156:159], a[132:135], v[156:159]
    ds_read_b64_tr_b16 a[198:199], v39 offset:32096
    v_mfma_f32_16x16x32_bf16 v[160:163], a[160:163], a[128:131], v[160:163]
    ds_read_b64_tr_b16 a[200:201], v38 offset:30848
    v_mfma_f32_16x16x32_bf16 v[164:167], a[160:163], a[132:135], v[164:167]
    ds_read_b64_tr_b16 a[202:203], v38 offset:32128
    s_waitcnt lgkmcnt(10)
    v_mfma_f32_16x16x32_bf16 v[168:171], a[164:167], a[128:131], v[168:171]
    ds_read_b64_tr_b16 a[204:205], v39 offset:30880
    buffer_load_dwordx4 v16, s[20:23], s65 offen offset:1024 lds
    v_mfma_f32_16x16x32_bf16 v[172:175], a[164:167], a[132:135], v[172:175]
    ds_read_b64_tr_b16 a[206:207], v39 offset:32160
    v_mfma_f32_16x16x32_bf16 v[176:179], a[168:171], a[128:131], v[176:179]
    ds_read_b64_tr_b16 a[208:209], v38 offset:30912
    v_mfma_f32_16x16x32_bf16 v[180:183], a[168:171], a[132:135], v[180:183]
    ds_read_b64_tr_b16 a[210:211], v38 offset:32192
    buffer_load_dwordx4 v17, s[20:23], s65 offen offset:2048 lds
    v_mfma_f32_16x16x32_bf16 v[184:187], a[172:175], a[128:131], v[184:187]
    ds_read_b64_tr_b16 a[212:213], v39 offset:30944
    v_mfma_f32_16x16x32_bf16 v[188:191], a[172:175], a[132:135], v[188:191]
    ds_read_b64_tr_b16 a[214:215], v39 offset:32224
    v_mfma_f32_16x16x32_bf16 v[192:195], a[176:179], a[128:131], v[192:195]
    ds_read_b64_tr_b16 a[216:217], v38 offset:30976
    v_mfma_f32_16x16x32_bf16 v[196:199], a[176:179], a[132:135], v[196:199]
    ds_read_b64_tr_b16 a[218:219], v38 offset:32256
    buffer_load_dwordx4 v18, s[20:23], s65 offen offset:3072 lds
    s_add_u32 m0, s38, 126976
    v_mfma_f32_16x16x32_bf16 v[200:203], a[180:183], a[128:131], v[200:203]
    ds_read_b64_tr_b16 a[220:221], v39 offset:31008
    v_mfma_f32_16x16x32_bf16 v[204:207], a[180:183], a[132:135], v[204:207]
    ds_read_b64_tr_b16 a[222:223], v39 offset:32288
    s_waitcnt lgkmcnt(10)
    s_waitcnt vmcnt(15)
    v_mfma_f32_16x16x32_bf16 v[128:131], a[184:187], a[136:139], v[128:131]
    s_barrier
    ds_read_b64_tr_b16 a[144:145], v42 offset:0
    buffer_load_dwordx4 v19, s[20:23], s65 offen lds
    s_add_u32 m0, s38, 40960
    v_mfma_f32_16x16x32_bf16 v[132:135], a[184:187], a[140:143], v[132:135]
    ds_read_b64_tr_b16 a[146:147], v42 offset:5120
    v_mfma_f32_16x16x32_bf16 v[136:139], a[188:191], a[136:139], v[136:139]
    ds_read_b64_tr_b16 a[148:149], v42 offset:32
    v_mfma_f32_16x16x32_bf16 v[140:143], a[188:191], a[140:143], v[140:143]
    ds_read_b64_tr_b16 a[150:151], v42 offset:5152
    v_mfma_f32_16x16x32_bf16 v[144:147], a[192:195], a[136:139], v[144:147]
    ds_read_b64_tr_b16 a[152:153], v42 offset:64
    buffer_load_dwordx4 v15, s[20:23], s66 offen offset:0 lds
    v_mfma_f32_16x16x32_bf16 v[148:151], a[192:195], a[140:143], v[148:151]
    ds_read_b64_tr_b16 a[154:155], v42 offset:5184
    v_mfma_f32_16x16x32_bf16 v[152:155], a[196:199], a[136:139], v[152:155]
    ds_read_b64_tr_b16 a[156:157], v42 offset:96
    v_mfma_f32_16x16x32_bf16 v[156:159], a[196:199], a[140:143], v[156:159]
    ds_read_b64_tr_b16 a[158:159], v42 offset:5216
    buffer_load_dwordx4 v16, s[20:23], s66 offen offset:1024 lds
    v_mfma_f32_16x16x32_bf16 v[160:163], a[200:203], a[136:139], v[160:163]
    ds_read_b64_tr_b16 a[160:161], v42 offset:128
    v_mfma_f32_16x16x32_bf16 v[164:167], a[200:203], a[140:143], v[164:167]
    ds_read_b64_tr_b16 a[162:163], v42 offset:5248
    s_waitcnt lgkmcnt(10)
    v_mfma_f32_16x16x32_bf16 v[168:171], a[204:207], a[136:139], v[168:171]
    ds_read_b64_tr_b16 a[164:165], v42 offset:160
    v_mfma_f32_16x16x32_bf16 v[172:175], a[204:207], a[140:143], v[172:175]
    ds_read_b64_tr_b16 a[166:167], v42 offset:5280
    buffer_load_dwordx4 v17, s[20:23], s66 offen offset:2048 lds
    v_mfma_f32_16x16x32_bf16 v[176:179], a[208:211], a[136:139], v[176:179]
    ds_read_b64_tr_b16 a[168:169], v42 offset:192
    v_mfma_f32_16x16x32_bf16 v[180:183], a[208:211], a[140:143], v[180:183]
    ds_read_b64_tr_b16 a[170:171], v42 offset:5312
    v_mfma_f32_16x16x32_bf16 v[184:187], a[212:215], a[136:139], v[184:187]
    ds_read_b64_tr_b16 a[172:173], v42 offset:224
    buffer_load_dwordx4 v18, s[20:23], s66 offen offset:3072 lds
    s_add_u32 m0, s38, 45056
    v_mfma_f32_16x16x32_bf16 v[188:191], a[212:215], a[140:143], v[188:191]
    ds_read_b64_tr_b16 a[174:175], v42 offset:5344
    v_mfma_f32_16x16x32_bf16 v[192:195], a[216:219], a[136:139], v[192:195]
    ds_read_b64_tr_b16 a[176:177], v42 offset:256
    v_mfma_f32_16x16x32_bf16 v[196:199], a[216:219], a[140:143], v[196:199]
    ds_read_b64_tr_b16 a[178:179], v42 offset:5376
    v_mfma_f32_16x16x32_bf16 v[200:203], a[220:223], a[136:139], v[200:203]
    buffer_load_dwordx4 v19, s[20:23], s66 offen lds
    s_add_u32 m0, s38, 143360
    v_mfma_f32_16x16x32_bf16 v[204:207], a[220:223], a[140:143], v[204:207]
    s_waitcnt lgkmcnt(8)
    v_mfma_f32_16x16x32_bf16 v[208:211], a[144:147], v[64:67], 0
    ds_read_b64_tr_b16 a[184:185], v42 offset:10240
    v_mfma_f32_16x16x32_bf16 v[212:215], a[144:147], v[68:71], 0
    ds_read_b64_tr_b16 a[186:187], v42 offset:15360
    buffer_load_dword v51, v49, s[16:19], 0 offen offset:0 sc1
    v_mfma_f32_16x16x32_bf16 v[216:219], a[148:151], v[64:67], 0
    ds_read_b64_tr_b16 a[188:189], v42 offset:10272
    buffer_load_dwordx4 v15, s[20:23], s67 offen offset:0 lds
    v_mul_f32 v128, v128, |v128|
    v_mfma_f32_16x16x32_bf16 v[220:223], a[148:151], v[68:71], 0
    ds_read_b64_tr_b16 a[190:191], v42 offset:15392
    v_mul_f32 v129, v129, |v129|
    v_mfma_f32_16x16x32_bf16 v[224:227], a[152:155], v[64:67], 0
    ds_read_b64_tr_b16 a[192:193], v42 offset:10304
    v_mul_f32 v130, v130, |v130|
    v_mfma_f32_16x16x32_bf16 v[228:231], a[152:155], v[68:71], 0
    ds_read_b64_tr_b16 a[194:195], v42 offset:15424
    v_mul_f32 v131, v131, |v131|
    v_mfma_f32_16x16x32_bf16 v[232:235], a[156:159], v[64:67], 0
    ds_read_b64_tr_b16 a[196:197], v42 offset:10336
    buffer_load_dwordx4 v16, s[20:23], s67 offen offset:1024 lds
    v_mul_f32 v136, v136, |v136|
    v_mul_f32 v137, v137, |v137|
    v_mfma_f32_16x16x32_bf16 v[236:239], a[156:159], v[68:71], 0
    ds_read_b64_tr_b16 a[198:199], v42 offset:15456
    v_mul_f32 v138, v138, |v138|
    v_mfma_f32_16x16x32_bf16 v[240:243], a[160:163], v[64:67], 0
    ds_read_b64_tr_b16 a[200:201], v42 offset:10368
    v_mul_f32 v139, v139, |v139|
    v_mfma_f32_16x16x32_bf16 v[244:247], a[160:163], v[68:71], 0
    ds_read_b64_tr_b16 a[202:203], v42 offset:15488
    buffer_load_dwordx4 v17, s[20:23], s67 offen offset:2048 lds
    v_cvt_pk_bf16_f32 v128, v128, v129
    s_waitcnt lgkmcnt(10)
    v_mfma_f32_16x16x32_bf16 v[72:75], a[164:167], v[64:67], 0
    ds_read_b64_tr_b16 a[204:205], v42 offset:10400
    v_cvt_pk_bf16_f32 v129, v130, v131
    v_cvt_pk_bf16_f32 v130, v136, v137
    v_mfma_f32_16x16x32_bf16 v[76:79], a[164:167], v[68:71], 0
    ds_read_b64_tr_b16 a[206:207], v42 offset:15520
    v_cvt_pk_bf16_f32 v131, v138, v139
    v_mfma_f32_16x16x32_bf16 v[88:91], a[168:171], v[64:67], 0
    ds_read_b64_tr_b16 a[208:209], v42 offset:10432
    v_pk_max_i16 v128, v128, 0
    v_mfma_f32_16x16x32_bf16 v[92:95], a[168:171], v[68:71], 0
    ds_read_b64_tr_b16 a[210:211], v42 offset:15552
    buffer_load_dwordx4 v18, s[20:23], s67 offen offset:3072 lds
    s_add_u32 m0, s38, 147456
    v_pk_max_i16 v129, v129, 0
    v_mfma_f32_16x16x32_bf16 v[104:107], a[172:175], v[64:67], 0
    ds_read_b64_tr_b16 a[212:213], v42 offset:10464
    v_pk_max_i16 v130, v130, 0
    v_mfma_f32_16x16x32_bf16 v[108:111], a[172:175], v[68:71], 0
    ds_read_b64_tr_b16 a[214:215], v42 offset:15584
    v_pk_max_i16 v131, v131, 0
    v_mul_f32 v132, v132, |v132|
    v_mfma_f32_16x16x32_bf16 v[120:123], a[176:179], v[64:67], 0
    ds_read_b64_tr_b16 a[216:217], v42 offset:10496
    buffer_load_dwordx4 v19, s[20:23], s67 offen lds
    s_add_u32 m0, s38, 61440
    v_mul_f32 v133, v133, |v133|
    v_mfma_f32_16x16x32_bf16 v[124:127], a[176:179], v[68:71], 0
    ds_read_b64_tr_b16 a[218:219], v42 offset:15616
    v_mul_f32 v134, v134, |v134|
    s_waitcnt lgkmcnt(8)
    s_waitcnt vmcnt(21)
    v_mfma_f32_16x16x32_bf16 v[208:211], a[184:187], v[80:83], v[208:211]
    s_barrier
    ds_read_b64_tr_b16 a[144:145], v43 offset:40960
    v_mul_f32 v135, v135, |v135|
    v_mfma_f32_16x16x32_bf16 v[212:215], a[184:187], v[84:87], v[212:215]
    ds_read_b64_tr_b16 a[146:147], v43 offset:46080
    v_mul_f32 v140, v140, |v140|
    v_mul_f32 v141, v141, |v141|
    v_mfma_f32_16x16x32_bf16 v[216:219], a[188:191], v[80:83], v[216:219]
    ds_read_b64_tr_b16 a[148:149], v43 offset:40992
    buffer_load_dwordx4 v15, s[20:23], s68 offen offset:0 lds
    v_mul_f32 v142, v142, |v142|
    v_mfma_f32_16x16x32_bf16 v[220:223], a[188:191], v[84:87], v[220:223]
    ds_read_b64_tr_b16 a[150:151], v43 offset:46112
    v_mul_f32 v143, v143, |v143|
    v_mfma_f32_16x16x32_bf16 v[224:227], a[192:195], v[80:83], v[224:227]
    ds_read_b64_tr_b16 a[152:153], v43 offset:41024
    v_cvt_pk_bf16_f32 v132, v132, v133
    v_mfma_f32_16x16x32_bf16 v[228:231], a[192:195], v[84:87], v[228:231]
    ds_read_b64_tr_b16 a[154:155], v43 offset:46144
    buffer_load_dwordx4 v16, s[20:23], s68 offen offset:1024 lds
    v_cvt_pk_bf16_f32 v133, v134, v135
    v_cvt_pk_bf16_f32 v134, v140, v141
    v_mfma_f32_16x16x32_bf16 v[232:235], a[196:199], v[80:83], v[232:235]
    ds_read_b64_tr_b16 a[156:157], v43 offset:41056
    v_cvt_pk_bf16_f32 v135, v142, v143
    v_mfma_f32_16x16x32_bf16 v[236:239], a[196:199], v[84:87], v[236:239]
    ds_read_b64_tr_b16 a[158:159], v43 offset:46176
    v_pk_max_i16 v132, v132, 0
    v_mfma_f32_16x16x32_bf16 v[240:243], a[200:203], v[80:83], v[240:243]
    ds_read_b64_tr_b16 a[160:161], v43 offset:41088
    v_pk_max_i16 v133, v133, 0
    v_mfma_f32_16x16x32_bf16 v[244:247], a[200:203], v[84:87], v[244:247]
    ds_read_b64_tr_b16 a[162:163], v43 offset:46208
    buffer_load_dwordx4 v17, s[20:23], s68 offen offset:2048 lds
    v_pk_max_i16 v134, v134, 0
    s_waitcnt lgkmcnt(10)
    v_mfma_f32_16x16x32_bf16 v[72:75], a[204:207], v[80:83], v[72:75]
    ds_read_b64_tr_b16 a[164:165], v43 offset:41120
    v_pk_max_i16 v135, v135, 0
    v_mul_f32 v144, v144, |v144|
    v_mfma_f32_16x16x32_bf16 v[76:79], a[204:207], v[84:87], v[76:79]
    ds_read_b64_tr_b16 a[166:167], v43 offset:46240
    v_mul_f32 v145, v145, |v145|
    v_mfma_f32_16x16x32_bf16 v[88:91], a[208:211], v[80:83], v[88:91]
    ds_read_b64_tr_b16 a[168:169], v43 offset:41152
    buffer_load_dwordx4 v18, s[20:23], s68 offen offset:3072 lds
    s_add_u32 m0, s38, 65536
    v_mul_f32 v146, v146, |v146|
    v_mfma_f32_16x16x32_bf16 v[92:95], a[208:211], v[84:87], v[92:95]
    ds_read_b64_tr_b16 a[170:171], v43 offset:46272
    v_mul_f32 v147, v147, |v147|
    v_mfma_f32_16x16x32_bf16 v[104:107], a[212:215], v[80:83], v[104:107]
    ds_read_b64_tr_b16 a[172:173], v43 offset:41184
    v_mul_f32 v152, v152, |v152|
    v_mul_f32 v153, v153, |v153|
    v_mfma_f32_16x16x32_bf16 v[108:111], a[212:215], v[84:87], v[108:111]
    ds_read_b64_tr_b16 a[174:175], v43 offset:46304
    v_mul_f32 v154, v154, |v154|
    v_mfma_f32_16x16x32_bf16 v[120:123], a[216:219], v[80:83], v[120:123]
    ds_read_b64_tr_b16 a[176:177], v43 offset:41216
    buffer_load_dwordx4 v19, s[20:23], s68 offen lds
    s_add_u32 m0, s38, 81920
    v_mul_f32 v155, v155, |v155|
    v_mfma_f32_16x16x32_bf16 v[124:127], a[216:219], v[84:87], v[124:127]
    ds_read_b64_tr_b16 a[178:179], v43 offset:46336
    v_cvt_pk_bf16_f32 v144, v144, v145
    s_waitcnt lgkmcnt(8)
    v_mfma_f32_16x16x32_bf16 v[208:211], a[144:147], v[96:99], v[208:211]
    ds_read_b64_tr_b16 a[184:185], v43 offset:51200
    v_cvt_pk_bf16_f32 v145, v146, v147
    v_cvt_pk_bf16_f32 v146, v152, v153
    v_mfma_f32_16x16x32_bf16 v[212:215], a[144:147], v[100:103], v[212:215]
    ds_read_b64_tr_b16 a[186:187], v43 offset:56320
    buffer_load_dwordx4 v15, s[20:23], s69 offen offset:0 lds
    v_cvt_pk_bf16_f32 v147, v154, v155
    v_mfma_f32_16x16x32_bf16 v[216:219], a[148:151], v[96:99], v[216:219]
    ds_read_b64_tr_b16 a[188:189], v43 offset:51232
    v_pk_max_i16 v144, v144, 0
    v_mfma_f32_16x16x32_bf16 v[220:223], a[148:151], v[100:103], v[220:223]
    ds_read_b64_tr_b16 a[190:191], v43 offset:56352
    v_pk_max_i16 v145, v145, 0
    v_mfma_f32_16x16x32_bf16 v[224:227], a[152:155], v[96:99], v[224:227]
    ds_read_b64_tr_b16 a[192:193], v43 offset:51264
    v_pk_max_i16 v146, v146, 0
    v_mfma_f32_16x16x32_bf16 v[228:231], a[152:155], v[100:103], v[228:231]
    ds_read_b64_tr_b16 a[194:195], v43 offset:56384
    buffer_load_dwordx4 v16, s[20:23], s69 offen offset:1024 lds
    v_pk_max_i16 v147, v147, 0
    v_mul_f32 v148, v148, |v148|
    v_mfma_f32_16x16x32_bf16 v[232:235], a[156:159], v[96:99], v[232:235]
    ds_read_b64_tr_b16 a[196:197], v43 offset:51296
    v_mul_f32 v149, v149, |v149|
    v_mfma_f32_16x16x32_bf16 v[236:239], a[156:159], v[100:103], v[236:239]
    ds_read_b64_tr_b16 a[198:199], v43 offset:56416
    v_mul_f32 v150, v150, |v150|
    v_mfma_f32_16x16x32_bf16 v[240:243], a[160:163], v[96:99], v[240:243]
    ds_read_b64_tr_b16 a[200:201], v43 offset:51328
    buffer_load_dwordx4 v17, s[20:23], s69 offen offset:2048 lds
    v_mul_f32 v151, v151, |v151|
    v_mfma_f32_16x16x32_bf16 v[244:247], a[160:163], v[100:103], v[244:247]
    ds_read_b64_tr_b16 a[202:203], v43 offset:56448
    v_mul_f32 v156, v156, |v156|
    v_mul_f32 v157, v157, |v157|
    s_waitcnt lgkmcnt(10)
    v_mfma_f32_16x16x32_bf16 v[72:75], a[164:167], v[96:99], v[72:75]
    ds_read_b64_tr_b16 a[204:205], v43 offset:51360
    v_mul_f32 v158, v158, |v158|
    v_mfma_f32_16x16x32_bf16 v[76:79], a[164:167], v[100:103], v[76:79]
    ds_read_b64_tr_b16 a[206:207], v43 offset:56480
    v_mul_f32 v159, v159, |v159|
    v_mfma_f32_16x16x32_bf16 v[88:91], a[168:171], v[96:99], v[88:91]
    ds_read_b64_tr_b16 a[208:209], v43 offset:51392
    buffer_load_dwordx4 v18, s[20:23], s69 offen offset:3072 lds
    s_add_u32 m0, s38, 86016
    v_cvt_pk_bf16_f32 v148, v148, v149
    v_mfma_f32_16x16x32_bf16 v[92:95], a[168:171], v[100:103], v[92:95]
    ds_read_b64_tr_b16 a[210:211], v43 offset:56512
    v_cvt_pk_bf16_f32 v149, v150, v151
    v_cvt_pk_bf16_f32 v150, v156, v157
    v_mfma_f32_16x16x32_bf16 v[104:107], a[172:175], v[96:99], v[104:107]
    ds_read_b64_tr_b16 a[212:213], v43 offset:51424
    v_cvt_pk_bf16_f32 v151, v158, v159
    v_mfma_f32_16x16x32_bf16 v[108:111], a[172:175], v[100:103], v[108:111]
    ds_read_b64_tr_b16 a[214:215], v43 offset:56544
    buffer_load_dwordx4 v19, s[20:23], s69 offen lds
    v_pk_max_i16 v148, v148, 0
    v_mfma_f32_16x16x32_bf16 v[120:123], a[176:179], v[96:99], v[120:123]
    ds_read_b64_tr_b16 a[216:217], v43 offset:51456
    v_pk_max_i16 v149, v149, 0
    v_mfma_f32_16x16x32_bf16 v[124:127], a[176:179], v[100:103], v[124:127]
    ds_read_b64_tr_b16 a[218:219], v43 offset:56576
    v_pk_max_i16 v150, v150, 0
    s_waitcnt lgkmcnt(8)
    s_waitcnt vmcnt(26)
    v_mfma_f32_16x16x32_bf16 v[208:211], a[184:187], v[112:115], v[208:211]
    s_barrier
    ds_read_b64_tr_b16 a[144:145], v42 offset:20480
    s_add_u32 m0, s38, 0
    s_waitcnt vmcnt(15)
    v_cmp_ne_u32 vcc, s43, v51
    s_nop 1
    s_cbranch_vccnz L_flag0_2_slow
L_flag0_2_back:
    v_pk_max_i16 v151, v151, 0
    v_mul_f32 v160, v160, |v160|
    v_mfma_f32_16x16x32_bf16 v[212:215], a[184:187], v[116:119], v[212:215]
    ds_read_b64_tr_b16 a[146:147], v42 offset:25600
    buffer_load_dwordx4 v15, s[20:23], s70 offen offset:0 lds
    v_mul_f32 v161, v161, |v161|
    v_mfma_f32_16x16x32_bf16 v[216:219], a[188:191], v[112:115], v[216:219]
    ds_read_b64_tr_b16 a[148:149], v42 offset:20512
    s_add_u32 s41, s81, 0
    v_mul_f32 v162, v162, |v162|
    v_mfma_f32_16x16x32_bf16 v[220:223], a[188:191], v[116:119], v[220:223]
    ds_read_b64_tr_b16 a[150:151], v42 offset:25632
    v_mul_f32 v163, v163, |v163|
    v_mfma_f32_16x16x32_bf16 v[224:227], a[192:195], v[112:115], v[224:227]
    ds_read_b64_tr_b16 a[152:153], v42 offset:20544
    buffer_load_dwordx4 a[0:3], v47, s[16:19], s41 offen offset:0 sc1
    v_mul_f32 v168, v168, |v168|
    v_mul_f32 v169, v169, |v169|
    v_mfma_f32_16x16x32_bf16 v[228:231], a[192:195], v[116:119], v[228:231]
    ds_read_b64_tr_b16 a[154:155], v42 offset:25664
    v_mul_f32 v170, v170, |v170|
    v_mfma_f32_16x16x32_bf16 v[232:235], a[196:199], v[112:115], v[232:235]
    ds_read_b64_tr_b16 a[156:157], v42 offset:20576
    v_mul_f32 v171, v171, |v171|
    v_mfma_f32_16x16x32_bf16 v[236:239], a[196:199], v[116:119], v[236:239]
    ds_read_b64_tr_b16 a[158:159], v42 offset:25696
    buffer_load_dwordx4 a[4:7], v47, s[16:19], s41 offen offset:1024 sc1
    s_add_u32 s41, s81, 8192
    v_cvt_pk_bf16_f32 v160, v160, v161
    v_mfma_f32_16x16x32_bf16 v[240:243], a[200:203], v[112:115], v[240:243]
    ds_read_b64_tr_b16 a[160:161], v42 offset:20608
    v_cvt_pk_bf16_f32 v161, v162, v163
    v_cvt_pk_bf16_f32 v162, v168, v169
    v_mfma_f32_16x16x32_bf16 v[244:247], a[200:203], v[116:119], v[244:247]
    ds_read_b64_tr_b16 a[162:163], v42 offset:25728
    v_cvt_pk_bf16_f32 v163, v170, v171
    s_waitcnt lgkmcnt(10)
    v_mfma_f32_16x16x32_bf16 v[72:75], a[204:207], v[112:115], v[72:75]
    ds_read_b64_tr_b16 a[164:165], v42 offset:20640
    buffer_load_dwordx4 a[8:11], v47, s[16:19], s41 offen offset:0 sc1
    v_pk_max_i16 v160, v160, 0
    v_mfma_f32_16x16x32_bf16 v[76:79], a[204:207], v[116:119], v[76:79]
    ds_read_b64_tr_b16 a[166:167], v42 offset:25760
    v_pk_max_i16 v161, v161, 0
    v_mfma_f32_16x16x32_bf16 v[88:91], a[208:211], v[112:115], v[88:91]
    ds_read_b64_tr_b16 a[168:169], v42 offset:20672
    v_pk_max_i16 v162, v162, 0
    v_mfma_f32_16x16x32_bf16 v[92:95], a[208:211], v[116:119], v[92:95]
    ds_read_b64_tr_b16 a[170:171], v42 offset:25792
    buffer_load_dwordx4 a[12:15], v47, s[16:19], s41 offen offset:1024 sc1
    v_pk_max_i16 v163, v163, 0
    v_mul_f32 v164, v164, |v164|
    v_mfma_f32_16x16x32_bf16 v[104:107], a[212:215], v[112:115], v[104:107]
    ds_read_b64_tr_b16 a[172:173], v42 offset:20704
    v_mul_f32 v165, v165, |v165|
    v_mfma_f32_16x16x32_bf16 v[108:111], a[212:215], v[116:119], v[108:111]
    ds_read_b64_tr_b16 a[174:175], v42 offset:25824
    v_mul_f32 v166, v166, |v166|
    v_mfma_f32_16x16x32_bf16 v[120:123], a[216:219], v[112:115], v[120:123]
    ds_read_b64_tr_b16 a[176:177], v42 offset:20736
    buffer_load_dwordx4 v16, s[20:23], s70 offen offset:1024 lds
    v_mul_f32 v167, v167, |v167|
    v_mfma_f32_16x16x32_bf16 v[124:127], a[216:219], v[116:119], v[124:127]
    ds_read_b64_tr_b16 a[178:179], v42 offset:25856
    v_mul_f32 v172, v172, |v172|
    v_mul_f32 v173, v173, |v173|
    s_waitcnt lgkmcnt(8)
    v_mfma_f32_16x16x32_bf16 v[208:211], a[144:147], v[128:131], v[208:211]
    ds_read_b64_tr_b16 a[184:185], v42 offset:30720
    v_mul_f32 v174, v174, |v174|
    v_mfma_f32_16x16x32_bf16 v[212:215], a[144:147], v[132:135], v[212:215]
    ds_read_b64_tr_b16 a[186:187], v42 offset:35840
    v_mul_f32 v175, v175, |v175|
    v_mfma_f32_16x16x32_bf16 v[216:219], a[148:151], v[128:131], v[216:219]
    ds_read_b64_tr_b16 a[188:189], v42 offset:30752
    buffer_load_dwordx4 v17, s[20:23], s70 offen offset:2048 lds
    s_add_u32 s41, s81, 16384
    v_cvt_pk_bf16_f32 v164, v164, v165
    v_mfma_f32_16x16x32_bf16 v[220:223], a[148:151], v[132:135], v[220:223]
    ds_read_b64_tr_b16 a[190:191], v42 offset:35872
    v_cvt_pk_bf16_f32 v165, v166, v167
    v_cvt_pk_bf16_f32 v166, v172, v173
    v_mfma_f32_16x16x32_bf16 v[224:227], a[152:155], v[128:131], v[224:227]
    ds_read_b64_tr_b16 a[192:193], v42 offset:30784
    v_cvt_pk_bf16_f32 v167, v174, v175
    v_mfma_f32_16x16x32_bf16 v[228:231], a[152:155], v[132:135], v[228:231]
    ds_read_b64_tr_b16 a[194:195], v42 offset:35904
    buffer_load_dwordx4 a[16:19], v47, s[16:19], s41 offen offset:0 sc1
    v_pk_max_i16 v164, v164, 0
    v_mfma_f32_16x16x32_bf16 v[232:235], a[156:159], v[128:131], v[232:235]
    ds_read_b64_tr_b16 a[196:197], v42 offset:30816
    v_pk_max_i16 v165, v165, 0
    v_mfma_f32_16x16x32_bf16 v[236:239], a[156:159], v[132:135], v[236:239]
    ds_read_b64_tr_b16 a[198:199], v42 offset:35936
    v_pk_max_i16 v166, v166, 0
    v_mfma_f32_16x16x32_bf16 v[240:243], a[160:163], v[128:131], v[240:243]
    ds_read_b64_tr_b16 a[200:201], v42 offset:30848
    buffer_load_dwordx4 a[20:23], v47, s[16:19], s41 offen offset:1024 sc1
    s_add_u32 s41, s81, 24576
    v_pk_max_i16 v167, v167, 0
    v_mfma_f32_16x16x32_bf16 v[244:247], a[160:163], v[132:135], v[244:247]
    ds_read_b64_tr_b16 a[202:203], v42 offset:35968
    s_add_u32 s42, s40, 32768
    v_mul_f32 v176, v176, |v176|
    s_waitcnt lgkmcnt(10)
    v_mfma_f32_16x16x32_bf16 v[72:75], a[164:167], v[128:131], v[72:75]
    ds_read_b64_tr_b16 a[204:205], v42 offset:30880
    v_mul_f32 v177, v177, |v177|
    v_mfma_f32_16x16x32_bf16 v[76:79], a[164:167], v[132:135], v[76:79]
    ds_read_b64_tr_b16 a[206:207], v42 offset:36000
    buffer_load_dwordx4 a[24:27], v47, s[16:19], s41 offen offset:0 sc1
    v_mul_f32 v178, v178, |v178|
    v_mfma_f32_16x16x32_bf16 v[88:91], a[168:171], v[128:131], v[88:91]
    ds_read_b64_tr_b16 a[208:209], v42 offset:30912
    v_mul_f32 v179, v179, |v179|
    v_mfma_f32_16x16x32_bf16 v[92:95], a[168:171], v[132:135], v[92:95]
    ds_read_b64_tr_b16 a[210:211], v42 offset:36032
    v_mul_f32 v184, v184, |v184|
    v_mfma_f32_16x16x32_bf16 v[104:107], a[172:175], v[128:131], v[104:107]
    ds_read_b64_tr_b16 a[212:213], v42 offset:30944
    buffer_store_dwordx4 v[128:131], v47, s[16:19], s42 offen offset:0 sc1
    v_mul_f32 v185, v185, |v185|
    v_mfma_f32_16x16x32_bf16 v[108:111], a[172:175], v[132:135], v[108:111]
    ds_read_b64_tr_b16 a[214:215], v42 offset:36064
    v_mul_f32 v186, v186, |v186|
    v_mfma_f32_16x16x32_bf16 v[120:123], a[176:179], v[128:131], v[120:123]
    ds_read_b64_tr_b16 a[216:217], v42 offset:30976
    v_mul_f32 v187, v187, |v187|
    v_mfma_f32_16x16x32_bf16 v[124:127], a[176:179], v[132:135], v[124:127]
    ds_read_b64_tr_b16 a[218:219], v42 offset:36096
    v_cvt_pk_bf16_f32 v176, v176, v177
    s_waitcnt lgkmcnt(8)
    v_mfma_f32_16x16x32_bf16 v[208:211], a[184:187], v[144:147], v[208:211]
    s_barrier
    ds_read_b64_tr_b16 a[144:145], v44 offset:0
    buffer_store_dwordx4 v[132:135], v47, s[16:19], s42 offen offset:1024 sc1
    s_add_u32 s42, s40, 40960
    v_cvt_pk_bf16_f32 v177, v178, v179
    v_mfma_f32_16x16x32_bf16 v[212:215], a[184:187], v[148:151], v[212:215]
    ds_read_b64_tr_b16 a[146:147], v44 offset:5120
    v_cvt_pk_bf16_f32 v178, v184, v185
    v_mfma_f32_16x16x32_bf16 v[216:219], a[188:191], v[144:147], v[216:219]
    ds_read_b64_tr_b16 a[148:149], v44 offset:32
    v_cvt_pk_bf16_f32 v179, v186, v187
    v_mfma_f32_16x16x32_bf16 v[220:223], a[188:191], v[148:151], v[220:223]
    ds_read_b64_tr_b16 a[150:151], v44 offset:5152
    v_pk_max_i16 v176, v176, 0
    v_mfma_f32_16x16x32_bf16 v[224:227], a[192:195], v[144:147], v[224:227]
    ds_read_b64_tr_b16 a[152:153], v44 offset:64
    buffer_store_dwordx4 v[144:147], v47, s[16:19], s42 offen offset:0 sc1
    v_mfma_f32_16x16x32_bf16 v[228:231], a[192:195], v[148:151], v[228:231]
    ds_read_b64_tr_b16 a[154:155], v44 offset:5184
    v_pk_max_i16 v177, v177, 0
    v_mfma_f32_16x16x32_bf16 v[232:235], a[196:199], v[144:147], v[232:235]
    ds_read_b64_tr_b16 a[156:157], v44 offset:96
    v_pk_max_i16 v178, v178, 0
    v_mfma_f32_16x16x32_bf16 v[236:239], a[196:199], v[148:151], v[236:239]
    ds_read_b64_tr_b16 a[158:159], v44 offset:5216
    v_pk_max_i16 v179, v179, 0
    v_mfma_f32_16x16x32_bf16 v[240:243], a[200:203], v[144:147], v[240:243]
    ds_read_b64_tr_b16 a[160:161], v44 offset:128
    buffer_store_dwordx4 v[148:151], v47, s[16:19], s42 offen offset:1024 sc1
    s_add_u32 s42, s40, 49152
    v_mul_f32 v180, v180, |v180|
    v_mfma_f32_16x16x32_bf16 v[244:247], a[200:203], v[148:151], v[244:247]
    ds_read_b64_tr_b16 a[162:163], v44 offset:5248
    v_mul_f32 v181, v181, |v181|
    s_waitcnt lgkmcnt(10)
    v_mfma_f32_16x16x32_bf16 v[72:75], a[204:207], v[144:147], v[72:75]
    ds_read_b64_tr_b16 a[164:165], v44 offset:160
    v_mul_f32 v182, v182, |v182|
    v_mfma_f32_16x16x32_bf16 v[76:79], a[204:207], v[148:151], v[76:79]
    ds_read_b64_tr_b16 a[166:167], v44 offset:5280
    v_mul_f32 v183, v183, |v183|
    v_mfma_f32_16x16x32_bf16 v[88:91], a[208:211], v[144:147], v[88:91]
    ds_read_b64_tr_b16 a[168:169], v44 offset:192
    buffer_store_dwordx4 v[160:163], v47, s[16:19], s42 offen offset:0 sc1
    v_mul_f32 v188, v188, |v188|
    v_mfma_f32_16x16x32_bf16 v[92:95], a[208:211], v[148:151], v[92:95]
    ds_read_b64_tr_b16 a[170:171], v44 offset:5312
    v_mul_f32 v189, v189, |v189|
    v_mfma_f32_16x16x32_bf16 v[104:107], a[212:215], v[144:147], v[104:107]
    ds_read_b64_tr_b16 a[172:173], v44 offset:224
    v_mul_f32 v190, v190, |v190|
    v_mfma_f32_16x16x32_bf16 v[108:111], a[212:215], v[148:151], v[108:111]
    ds_read_b64_tr_b16 a[174:175], v44 offset:5344
    v_mul_f32 v191, v191, |v191|
    v_mfma_f32_16x16x32_bf16 v[120:123], a[216:219], v[144:147], v[120:123]
    ds_read_b64_tr_b16 a[176:177], v44 offset:256
    buffer_store_dwordx4 v[164:167], v47, s[16:19], s42 offen offset:1024 sc1
    v_mfma_f32_16x16x32_bf16 v[124:127], a[216:219], v[148:151], v[124:127]
    ds_read_b64_tr_b16 a[178:179], v44 offset:5376
    v_cvt_pk_bf16_f32 v180, v180, v181
    s_waitcnt lgkmcnt(8)
    v_mfma_f32_16x16x32_bf16 v[208:211], a[144:147], v[160:163], v[208:211]
    ds_read_b64_tr_b16 a[184:185], v44 offset:10240
    v_cvt_pk_bf16_f32 v181, v182, v183
    v_mfma_f32_16x16x32_bf16 v[212:215], a[144:147], v[164:167], v[212:215]
    ds_read_b64_tr_b16 a[186:187], v44 offset:15360
    v_cvt_pk_bf16_f32 v182, v188, v189
    v_mfma_f32_16x16x32_bf16 v[216:219], a[148:151], v[160:163], v[216:219]
    ds_read_b64_tr_b16 a[188:189], v44 offset:10272
    buffer_load_dwordx4 a[28:31], v47, s[16:19], s41 offen offset:1024 sc1
    v_cvt_pk_bf16_f32 v183, v190, v191
    v_mfma_f32_16x16x32_bf16 v[220:223], a[148:151], v[164:167], v[220:223]
    ds_read_b64_tr_b16 a[190:191], v44 offset:15392
    v_pk_max_i16 v180, v180, 0
    v_mfma_f32_16x16x32_bf16 v[224:227], a[152:155], v[160:163], v[224:227]
    ds_read_b64_tr_b16 a[192:193], v44 offset:10304
    v_pk_max_i16 v181, v181, 0
    v_mfma_f32_16x16x32_bf16 v[228:231], a[152:155], v[164:167], v[228:231]
    ds_read_b64_tr_b16 a[194:195], v44 offset:15424
    buffer_load_dwordx4 v18, s[20:23], s70 offen offset:3072 lds
    s_add_u32 m0, s38, 4096
    v_pk_max_i16 v182, v182, 0
    v_mfma_f32_16x16x32_bf16 v[232:235], a[156:159], v[160:163], v[232:235]
    ds_read_b64_tr_b16 a[196:197], v44 offset:10336
    v_pk_max_i16 v183, v183, 0
    v_mfma_f32_16x16x32_bf16 v[236:239], a[156:159], v[164:167], v[236:239]
    ds_read_b64_tr_b16 a[198:199], v44 offset:15456
    v_mul_f32 v192, v192, |v192|
    v_mfma_f32_16x16x32_bf16 v[240:243], a[160:163], v[160:163], v[240:243]
    ds_read_b64_tr_b16 a[200:201], v44 offset:10368
    v_mul_f32 v193, v193, |v193|
    v_mfma_f32_16x16x32_bf16 v[244:247], a[160:163], v[164:167], v[244:247]
    ds_read_b64_tr_b16 a[202:203], v44 offset:15488
    buffer_load_dwordx4 v19, s[20:23], s70 offen lds
    s_add_u32 m0, s38, 102400
    s_waitcnt lgkmcnt(10)
    v_mfma_f32_16x16x32_bf16 v[72:75], a[164:167], v[160:163], v[72:75]
    ds_read_b64_tr_b16 a[204:205], v44 offset:10400
    v_mul_f32 v194, v194, |v194|
    v_mfma_f32_16x16x32_bf16 v[76:79], a[164:167], v[164:167], v[76:79]
    ds_read_b64_tr_b16 a[206:207], v44 offset:15520
    v_mul_f32 v195, v195, |v195|
    v_mfma_f32_16x16x32_bf16 v[88:91], a[168:171], v[160:163], v[88:91]
    ds_read_b64_tr_b16 a[208:209], v44 offset:10432
    buffer_load_dwordx4 v15, s[20:23], s71 offen offset:0 lds
    v_mul_f32 v200, v200, |v200|
    v_mfma_f32_16x16x32_bf16 v[92:95], a[168:171], v[164:167], v[92:95]
    ds_read_b64_tr_b16 a[210:211], v44 offset:15552
    v_mul_f32 v201, v201, |v201|
    v_mfma_f32_16x16x32_bf16 v[104:107], a[172:175], v[160:163], v[104:107]
    ds_read_b64_tr_b16 a[212:213], v44 offset:10464
    v_mul_f32 v202, v202, |v202|
    v_mfma_f32_16x16x32_bf16 v[108:111], a[172:175], v[164:167], v[108:111]
    ds_read_b64_tr_b16 a[214:215], v44 offset:15584
    v_mul_f32 v203, v203, |v203|
    v_mfma_f32_16x16x32_bf16 v[120:123], a[176:179], v[160:163], v[120:123]
    ds_read_b64_tr_b16 a[216:217], v44 offset:10496
    buffer_load_dwordx4 v16, s[20:23], s71 offen offset:1024 lds
    v_cvt_pk_bf16_f32 v192, v192, v193
    v_mfma_f32_16x16x32_bf16 v[124:127], a[176:179], v[164:167], v[124:127]
    ds_read_b64_tr_b16 a[218:219], v44 offset:15616
    v_cvt_pk_bf16_f32 v193, v194, v195
    s_waitcnt lgkmcnt(8)
    v_mfma_f32_16x16x32_bf16 v[208:211], a[184:187], v[176:179], v[208:211]
    s_barrier
    ds_read_b64_tr_b16 a[144:145], v42 offset:40960
    v_mfma_f32_16x16x32_bf16 v[212:215], a[184:187], v[180:183], v[212:215]
    ds_read_b64_tr_b16 a[146:147], v42 offset:46080
    buffer_load_dwordx4 v17, s[20:23], s71 offen offset:2048 lds
    v_cvt_pk_bf16_f32 v194, v200, v201
    v_mfma_f32_16x16x32_bf16 v[216:219], a[188:191], v[176:179], v[216:219]
    ds_read_b64_tr_b16 a[148:149], v42 offset:40992
    v_cvt_pk_bf16_f32 v195, v202, v203
    v_mfma_f32_16x16x32_bf16 v[220:223], a[188:191], v[180:183], v[220:223]
    ds_read_b64_tr_b16 a[150:151], v42 offset:46112
    v_pk_max_i16 v192, v192, 0
    v_mfma_f32_16x16x32_bf16 v[224:227], a[192:195], v[176:179], v[224:227]
    ds_read_b64_tr_b16 a[152:153], v42 offset:41024
    v_pk_max_i16 v193, v193, 0
    v_mfma_f32_16x16x32_bf16 v[228:231], a[192:195], v[180:183], v[228:231]
    ds_read_b64_tr_b16 a[154:155], v42 offset:46144
    buffer_load_dwordx4 v18, s[20:23], s71 offen offset:3072 lds
    s_add_u32 m0, s38, 106496
    v_pk_max_i16 v194, v194, 0
    v_mfma_f32_16x16x32_bf16 v[232:235], a[196:199], v[176:179], v[232:235]
    ds_read_b64_tr_b16 a[156:157], v42 offset:41056
    v_pk_max_i16 v195, v195, 0
    v_mfma_f32_16x16x32_bf16 v[236:239], a[196:199], v[180:183], v[236:239]
    ds_read_b64_tr_b16 a[158:159], v42 offset:46176
    v_mul_f32 v196, v196, |v196|
    v_mfma_f32_16x16x32_bf16 v[240:243], a[200:203], v[176:179], v[240:243]
    ds_read_b64_tr_b16 a[160:161], v42 offset:41088
    buffer_load_dwordx4 v19, s[20:23], s71 offen lds
    v_mul_f32 v197, v197, |v197|
    v_mfma_f32_16x16x32_bf16 v[244:247], a[200:203], v[180:183], v[244:247]
    ds_read_b64_tr_b16 a[162:163], v42 offset:46208
    v_mul_f32 v198, v198, |v198|
    s_waitcnt lgkmcnt(10)
    v_mfma_f32_16x16x32_bf16 v[72:75], a[204:207], v[176:179], v[72:75]
    ds_read_b64_tr_b16 a[164:165], v42 offset:41120
    v_mul_f32 v199, v199, |v199|
    v_mfma_f32_16x16x32_bf16 v[76:79], a[204:207], v[180:183], v[76:79]
    ds_read_b64_tr_b16 a[166:167], v42 offset:46240
    v_mul_f32 v204, v204, |v204|
    v_mfma_f32_16x16x32_bf16 v[88:91], a[208:211], v[176:179], v[88:91]
    ds_read_b64_tr_b16 a[168:169], v42 offset:41152
    v_mul_f32 v205, v205, |v205|
    v_mfma_f32_16x16x32_bf16 v[92:95], a[208:211], v[180:183], v[92:95]
    ds_read_b64_tr_b16 a[170:171], v42 offset:46272
    v_mul_f32 v206, v206, |v206|
    v_mfma_f32_16x16x32_bf16 v[104:107], a[212:215], v[176:179], v[104:107]
    ds_read_b64_tr_b16 a[172:173], v42 offset:41184
    v_mul_f32 v207, v207, |v207|
    v_cvt_pk_bf16_f32 v196, v196, v197
    v_cvt_pk_bf16_f32 v197, v198, v199
    v_cvt_pk_bf16_f32 v198, v204, v205
    v_cvt_pk_bf16_f32 v199, v206, v207
    v_pk_max_i16 v196, v196, 0
    v_pk_max_i16 v197, v197, 0
    v_pk_max_i16 v198, v198, 0
    v_pk_max_i16 v199, v199, 0
    v_mfma_f32_16x16x32_bf16 v[108:111], a[212:215], v[180:183], v[108:111]
    ds_read_b64_tr_b16 a[174:175], v42 offset:46304
    v_mfma_f32_16x16x32_bf16 v[120:123], a[216:219], v[176:179], v[120:123]
    ds_read_b64_tr_b16 a[176:177], v42 offset:41216
    v_mfma_f32_16x16x32_bf16 v[124:127], a[216:219], v[180:183], v[124:127]
    ds_read_b64_tr_b16 a[178:179], v42 offset:46336
    s_waitcnt lgkmcnt(8)
    v_mfma_f32_16x16x32_bf16 v[208:211], a[144:147], v[192:195], v[208:211]
    ds_read_b64_tr_b16 a[184:185], v42 offset:51200
    v_mfma_f32_16x16x32_bf16 v[212:215], a[144:147], v[196:199], v[212:215]
    ds_read_b64_tr_b16 a[186:187], v42 offset:56320
    v_mfma_f32_16x16x32_bf16 v[216:219], a[148:151], v[192:195], v[216:219]
    ds_read_b64_tr_b16 a[188:189], v42 offset:51232
    s_add_u32 m0, s38, 20480
    v_mfma_f32_16x16x32_bf16 v[220:223], a[148:151], v[196:199], v[220:223]
    ds_read_b64_tr_b16 a[190:191], v42 offset:56352
    buffer_load_dwordx4 v15, s[20:23], s72 offen offset:0 lds
    v_mfma_f32_16x16x32_bf16 v[224:227], a[152:155], v[192:195], v[224:227]
    ds_read_b64_tr_b16 a[192:193], v42 offset:51264
    v_mfma_f32_16x16x32_bf16 v[228:231], a[152:155], v[196:199], v[228:231]
    ds_read_b64_tr_b16 a[194:195], v42 offset:56384
    v_mfma_f32_16x16x32_bf16 v[232:235], a[156:159], v[192:195], v[232:235]
    ds_read_b64_tr_b16 a[196:197], v42 offset:51296
    buffer_load_dwordx4 v16, s[20:23], s72 offen offset:1024 lds
    v_mfma_f32_16x16x32_bf16 v[236:239], a[156:159], v[196:199], v[236:239]
    ds_read_b64_tr_b16 a[198:199], v42 offset:56416
    v_mfma_f32_16x16x32_bf16 v[240:243], a[160:163], v[192:195], v[240:243]
    ds_read_b64_tr_b16 a[200:201], v42 offset:51328
    v_mfma_f32_16x16x32_bf16 v[244:247], a[160:163], v[196:199], v[244:247]
    ds_read_b64_tr_b16 a[202:203], v42 offset:56448
    buffer_load_dwordx4 v17, s[20:23], s72 offen offset:2048 lds
    s_waitcnt lgkmcnt(10)
    v_mfma_f32_16x16x32_bf16 v[72:75], a[164:167], v[192:195], v[72:75]
    ds_read_b64_tr_b16 a[204:205], v42 offset:51360
    v_mfma_f32_16x16x32_bf16 v[76:79], a[164:167], v[196:199], v[76:79]
    ds_read_b64_tr_b16 a[206:207], v42 offset:56480
    v_mfma_f32_16x16x32_bf16 v[88:91], a[168:171], v[192:195], v[88:91]
    ds_read_b64_tr_b16 a[208:209], v42 offset:51392
    v_mfma_f32_16x16x32_bf16 v[92:95], a[168:171], v[196:199], v[92:95]
    ds_read_b64_tr_b16 a[210:211], v42 offset:56512
    buffer_load_dwordx4 v18, s[20:23], s72 offen offset:3072 lds
    s_add_u32 m0, s38, 24576
    v_mfma_f32_16x16x32_bf16 v[104:107], a[172:175], v[192:195], v[104:107]
    ds_read_b64_tr_b16 a[212:213], v42 offset:51424
    v_mfma_f32_16x16x32_bf16 v[108:111], a[172:175], v[196:199], v[108:111]
    ds_read_b64_tr_b16 a[214:215], v42 offset:56544
    v_mfma_f32_16x16x32_bf16 v[120:123], a[176:179], v[192:195], v[120:123]
    ds_read_b64_tr_b16 a[216:217], v42 offset:51456
    buffer_load_dwordx4 v19, s[20:23], s72 offen lds
    v_mfma_f32_16x16x32_bf16 v[124:127], a[176:179], v[196:199], v[124:127]
    ds_read_b64_tr_b16 a[218:219], v42 offset:56576
    s_waitcnt lgkmcnt(8)
    s_waitcnt vmcnt(26)
    v_mfma_f32_16x16x32_bf16 v[208:211], a[184:187], a[0:3], v[208:211]
    s_barrier
    ds_read_b64_tr_b16 a[144:145], v44 offset:20480
    v_mfma_f32_16x16x32_bf16 v[212:215], a[184:187], a[4:7], v[212:215]
    ds_read_b64_tr_b16 a[146:147], v44 offset:25600
    v_mfma_f32_16x16x32_bf16 v[216:219], a[188:191], a[0:3], v[216:219]
    ds_read_b64_tr_b16 a[148:149], v44 offset:20512
    s_add_u32 s41, s82, 0
    v_mfma_f32_16x16x32_bf16 v[220:223], a[188:191], a[4:7], v[220:223]
    ds_read_b64_tr_b16 a[150:151], v44 offset:25632
    v_mfma_f32_16x16x32_bf16 v[224:227], a[192:195], a[0:3], v[224:227]
    ds_read_b64_tr_b16 a[152:153], v44 offset:20544
    buffer_load_dwordx4 a[32:35], v47, s[16:19], s41 offen offset:0 sc1
    v_mfma_f32_16x16x32_bf16 v[228:231], a[192:195], a[4:7], v[228:231]
    ds_read_b64_tr_b16 a[154:155], v44 offset:25664
    v_mfma_f32_16x16x32_bf16 v[232:235], a[196:199], a[0:3], v[232:235]
    ds_read_b64_tr_b16 a[156:157], v44 offset:20576
    buffer_load_dwordx4 a[36:39], v47, s[16:19], s41 offen offset:1024 sc1
    v_mfma_f32_16x16x32_bf16 v[236:239], a[196:199], a[4:7], v[236:239]
    ds_read_b64_tr_b16 a[158:159], v44 offset:25696
    v_mfma_f32_16x16x32_bf16 v[240:243], a[200:203], a[0:3], v[240:243]
    ds_read_b64_tr_b16 a[160:161], v44 offset:20608
    v_mfma_f32_16x16x32_bf16 v[244:247], a[200:203], a[4:7], v[244:247]
    ds_read_b64_tr_b16 a[162:163], v44 offset:25728
    s_waitcnt lgkmcnt(10)
    v_mfma_f32_16x16x32_bf16 v[72:75], a[204:207], a[0:3], v[72:75]
    ds_read_b64_tr_b16 a[164:165], v44 offset:20640
    v_mfma_f32_16x16x32_bf16 v[76:79], a[204:207], a[4:7], v[76:79]
    ds_read_b64_tr_b16 a[166:167], v44 offset:25760
    v_mfma_f32_16x16x32_bf16 v[88:91], a[208:211], a[0:3], v[88:91]
    ds_read_b64_tr_b16 a[168:169], v44 offset:20672
    v_mfma_f32_16x16x32_bf16 v[92:95], a[208:211], a[4:7], v[92:95]
    ds_read_b64_tr_b16 a[170:171], v44 offset:25792
    v_mfma_f32_16x16x32_bf16 v[104:107], a[212:215], a[0:3], v[104:107]
    ds_read_b64_tr_b16 a[172:173], v44 offset:20704
    v_mfma_f32_16x16x32_bf16 v[108:111], a[212:215], a[4:7], v[108:111]
    ds_read_b64_tr_b16 a[174:175], v44 offset:25824
    v_mfma_f32_16x16x32_bf16 v[120:123], a[216:219], a[0:3], v[120:123]
    ds_read_b64_tr_b16 a[176:177], v44 offset:20736
    v_mfma_f32_16x16x32_bf16 v[124:127], a[216:219], a[4:7], v[124:127]
    ds_read_b64_tr_b16 a[178:179], v44 offset:25856
    s_waitcnt lgkmcnt(8)
    s_waitcnt vmcnt(26)
    v_mfma_f32_16x16x32_bf16 v[208:211], a[144:147], a[8:11], v[208:211]
    ds_read_b64_tr_b16 a[184:185], v44 offset:30720
    v_mfma_f32_16x16x32_bf16 v[212:215], a[144:147], a[12:15], v[212:215]
    ds_read_b64_tr_b16 a[186:187], v44 offset:35840
    v_mfma_f32_16x16x32_bf16 v[216:219], a[148:151], a[8:11], v[216:219]
    ds_read_b64_tr_b16 a[188:189], v44 offset:30752
    s_add_u32 s41, s82, 8192
    v_mfma_f32_16x16x32_bf16 v[220:223], a[148:151], a[12:15], v[220:223]
    ds_read_b64_tr_b16 a[190:191], v44 offset:35872
    v_mfma_f32_16x16x32_bf16 v[224:227], a[152:155], a[8:11], v[224:227]
    ds_read_b64_tr_b16 a[192:193], v44 offset:30784
    buffer_load_dwordx4 a[40:43], v47, s[16:19], s41 offen offset:0 sc1
    v_mfma_f32_16x16x32_bf16 v[228:231], a[152:155], a[12:15], v[228:231]
    ds_read_b64_tr_b16 a[194:195], v44 offset:35904
    v_mfma_f32_16x16x32_bf16 v[232:235], a[156:159], a[8:11], v[232:235]
    ds_read_b64_tr_b16 a[196:197], v44 offset:30816
    buffer_load_dwordx4 a[44:47], v47, s[16:19], s41 offen offset:1024 sc1
    v_mfma_f32_16x16x32_bf16 v[236:239], a[156:159], a[12:15], v[236:239]
    ds_read_b64_tr_b16 a[198:199], v44 offset:35936
    v_mfma_f32_16x16x32_bf16 v[240:243], a[160:163], a[8:11], v[240:243]
    ds_read_b64_tr_b16 a[200:201], v44 offset:30848
    v_mfma_f32_16x16x32_bf16 v[244:247], a[160:163], a[12:15], v[244:247]
    ds_read_b64_tr_b16 a[202:203], v44 offset:35968
    s_waitcnt lgkmcnt(10)
    v_mfma_f32_16x16x32_bf16 v[72:75], a[164:167], a[8:11], v[72:75]
    ds_read_b64_tr_b16 a[204:205], v44 offset:30880
    v_mfma_f32_16x16x32_bf16 v[76:79], a[164:167], a[12:15], v[76:79]
    ds_read_b64_tr_b16 a[206:207], v44 offset:36000
    v_mfma_f32_16x16x32_bf16 v[88:91], a[168:171], a[8:11], v[88:91]
    ds_read_b64_tr_b16 a[208:209], v44 offset:30912
    v_mfma_f32_16x16x32_bf16 v[92:95], a[168:171], a[12:15], v[92:95]
    ds_read_b64_tr_b16 a[210:211], v44 offset:36032
    v_mfma_f32_16x16x32_bf16 v[104:107], a[172:175], a[8:11], v[104:107]
    ds_read_b64_tr_b16 a[212:213], v44 offset:30944
    v_mfma_f32_16x16x32_bf16 v[108:111], a[172:175], a[12:15], v[108:111]
    ds_read_b64_tr_b16 a[214:215], v44 offset:36064
    s_add_u32 m0, s38, 122880
    v_mfma_f32_16x16x32_bf16 v[120:123], a[176:179], a[8:11], v[120:123]
    ds_read_b64_tr_b16 a[216:217], v44 offset:30976
    buffer_load_dwordx4 v15, s[20:23], s73 offen offset:0 lds
    v_mfma_f32_16x16x32_bf16 v[124:127], a[176:179], a[12:15], v[124:127]
    ds_read_b64_tr_b16 a[218:219], v44 offset:36096
    s_waitcnt lgkmcnt(8)
    s_waitcnt vmcnt(25)
    s_waitcnt vmcnt(18)
    v_mfma_f32_16x16x32_bf16 v[208:211], a[184:187], a[16:19], v[208:211]
    s_barrier
    ds_read_b64_tr_b16 a[144:145], v43 offset:0
    v_mfma_f32_16x16x32_bf16 v[212:215], a[184:187], a[20:23], v[212:215]
    ds_read_b64_tr_b16 a[146:147], v43 offset:5120
    buffer_load_dwordx4 v16, s[20:23], s73 offen offset:1024 lds
    v_mfma_f32_16x16x32_bf16 v[216:219], a[188:191], a[16:19], v[216:219]
    ds_read_b64_tr_b16 a[148:149], v43 offset:32
    s_add_u32 s41, s82, 16384
    v_mfma_f32_16x16x32_bf16 v[220:223], a[188:191], a[20:23], v[220:223]
    ds_read_b64_tr_b16 a[150:151], v43 offset:5152
    v_mfma_f32_16x16x32_bf16 v[224:227], a[192:195], a[16:19], v[224:227]
    ds_read_b64_tr_b16 a[152:153], v43 offset:64
    buffer_store_dword v52, v50, s[16:19], 0 offen offset:4 sc1
    v_mfma_f32_16x16x32_bf16 v[228:231], a[192:195], a[20:23], v[228:231]
    ds_read_b64_tr_b16 a[154:155], v43 offset:5184
    buffer_load_dwordx4 a[48:51], v47, s[16:19], s41 offen offset:0 sc1
    v_mfma_f32_16x16x32_bf16 v[232:235], a[196:199], a[16:19], v[232:235]
    ds_read_b64_tr_b16 a[156:157], v43 offset:96
    v_mfma_f32_16x16x32_bf16 v[236:239], a[196:199], a[20:23], v[236:239]
    ds_read_b64_tr_b16 a[158:159], v43 offset:5216
    buffer_load_dwordx4 a[52:55], v47, s[16:19], s41 offen offset:1024 sc1
    v_mfma_f32_16x16x32_bf16 v[240:243], a[200:203], a[16:19], v[240:243]
    ds_read_b64_tr_b16 a[160:161], v43 offset:128
    v_mfma_f32_16x16x32_bf16 v[244:247], a[200:203], a[20:23], v[244:247]
    ds_read_b64_tr_b16 a[162:163], v43 offset:5248
    s_waitcnt lgkmcnt(10)
    v_mfma_f32_16x16x32_bf16 v[72:75], a[204:207], a[16:19], v[72:75]
    ds_read_b64_tr_b16 a[164:165], v43 offset:160
    buffer_load_dwordx4 v17, s[20:23], s73 offen offset:2048 lds
    v_mfma_f32_16x16x32_bf16 v[76:79], a[204:207], a[20:23], v[76:79]
    ds_read_b64_tr_b16 a[166:167], v43 offset:5280
    v_mfma_f32_16x16x32_bf16 v[88:91], a[208:211], a[16:19], v[88:91]
    ds_read_b64_tr_b16 a[168:169], v43 offset:192
    v_mfma_f32_16x16x32_bf16 v[92:95], a[208:211], a[20:23], v[92:95]
    ds_read_b64_tr_b16 a[170:171], v43 offset:5312
    v_mfma_f32_16x16x32_bf16 v[104:107], a[212:215], a[16:19], v[104:107]
    ds_read_b64_tr_b16 a[172:173], v43 offset:224
    buffer_load_dwordx4 v18, s[20:23], s73 offen offset:3072 lds
    s_add_u32 m0, s38, 126976
    v_mfma_f32_16x16x32_bf16 v[108:111], a[212:215], a[20:23], v[108:111]
    ds_read_b64_tr_b16 a[174:175], v43 offset:5344
    v_mfma_f32_16x16x32_bf16 v[120:123], a[216:219], a[16:19], v[120:123]
    ds_read_b64_tr_b16 a[176:177], v43 offset:256
    v_mfma_f32_16x16x32_bf16 v[124:127], a[216:219], a[20:23], v[124:127]
    ds_read_b64_tr_b16 a[178:179], v43 offset:5376
    buffer_load_dwordx4 v19, s[20:23], s73 offen lds
    s_waitcnt lgkmcnt(8)
    s_waitcnt vmcnt(24)
    v_mfma_f32_16x16x32_bf16 v[208:211], a[144:147], a[24:27], v[208:211]
    ds_read_b64_tr_b16 a[184:185], v43 offset:10240
    v_mfma_f32_16x16x32_bf16 v[212:215], a[144:147], a[28:31], v[212:215]
    ds_read_b64_tr_b16 a[186:187], v43 offset:15360
    v_mfma_f32_16x16x32_bf16 v[216:219], a[148:151], a[24:27], v[216:219]
    ds_read_b64_tr_b16 a[188:189], v43 offset:10272
    s_add_u32 s41, s82, 24576
    v_mfma_f32_16x16x32_bf16 v[220:223], a[148:151], a[28:31], v[220:223]
    ds_read_b64_tr_b16 a[190:191], v43 offset:15392
    v_mfma_f32_16x16x32_bf16 v[224:227], a[152:155], a[24:27], v[224:227]
    ds_read_b64_tr_b16 a[192:193], v43 offset:10304
    buffer_load_dwordx4 a[56:59], v47, s[16:19], s41 offen offset:0 sc1
    v_mfma_f32_16x16x32_bf16 v[228:231], a[152:155], a[28:31], v[228:231]
    ds_read_b64_tr_b16 a[194:195], v43 offset:15424
    v_mfma_f32_16x16x32_bf16 v[232:235], a[156:159], a[24:27], v[232:235]
    ds_read_b64_tr_b16 a[196:197], v43 offset:10336
    buffer_load_dwordx4 a[60:63], v47, s[16:19], s41 offen offset:1024 sc1
    v_mfma_f32_16x16x32_bf16 v[236:239], a[156:159], a[28:31], v[236:239]
    ds_read_b64_tr_b16 a[198:199], v43 offset:15456
    v_mfma_f32_16x16x32_bf16 v[240:243], a[160:163], a[24:27], v[240:243]
    ds_read_b64_tr_b16 a[200:201], v43 offset:10368
    v_mfma_f32_16x16x32_bf16 v[244:247], a[160:163], a[28:31], v[244:247]
    ds_read_b64_tr_b16 a[202:203], v43 offset:15488
    s_waitcnt lgkmcnt(10)
    v_mfma_f32_16x16x32_bf16 v[72:75], a[164:167], a[24:27], v[72:75]
    ds_read_b64_tr_b16 a[204:205], v43 offset:10400
    v_mfma_f32_16x16x32_bf16 v[76:79], a[164:167], a[28:31], v[76:79]
    ds_read_b64_tr_b16 a[206:207], v43 offset:15520
    s_add_u32 s42, s40, 57344
    v_mfma_f32_16x16x32_bf16 v[88:91], a[168:171], a[24:27], v[88:91]
    ds_read_b64_tr_b16 a[208:209], v43 offset:10432
    v_mfma_f32_16x16x32_bf16 v[92:95], a[168:171], a[28:31], v[92:95]
    ds_read_b64_tr_b16 a[210:211], v43 offset:15552
    v_mfma_f32_16x16x32_bf16 v[104:107], a[172:175], a[24:27], v[104:107]
    ds_read_b64_tr_b16 a[212:213], v43 offset:10464
    buffer_store_dwordx4 v[176:179], v47, s[16:19], s42 offen offset:0 sc1
    v_mfma_f32_16x16x32_bf16 v[108:111], a[172:175], a[28:31], v[108:111]
    ds_read_b64_tr_b16 a[214:215], v43 offset:15584
    v_mfma_f32_16x16x32_bf16 v[120:123], a[176:179], a[24:27], v[120:123]
    ds_read_b64_tr_b16 a[216:217], v43 offset:10496
    v_mfma_f32_16x16x32_bf16 v[124:127], a[176:179], a[28:31], v[124:127]
    ds_read_b64_tr_b16 a[218:219], v43 offset:15616
    buffer_store_dwordx4 v[180:183], v47, s[16:19], s42 offen offset:1024 sc1
    s_add_u32 s42, s40, 65536
    s_waitcnt lgkmcnt(8)
    s_waitcnt vmcnt(14)
    v_mfma_f32_16x16x32_bf16 v[208:211], a[184:187], a[32:35], v[208:211]
    s_barrier
    ds_read_b64_tr_b16 a[144:145], v43 offset:20480
    v_mfma_f32_16x16x32_bf16 v[212:215], a[184:187], a[36:39], v[212:215]
    ds_read_b64_tr_b16 a[146:147], v43 offset:25600
    v_mfma_f32_16x16x32_bf16 v[216:219], a[188:191], a[32:35], v[216:219]
    ds_read_b64_tr_b16 a[148:149], v43 offset:20512
    s_add_u32 s41, s83, 0
    v_mfma_f32_16x16x32_bf16 v[220:223], a[188:191], a[36:39], v[220:223]
    ds_read_b64_tr_b16 a[150:151], v43 offset:25632
    buffer_store_dwordx4 v[192:195], v47, s[16:19], s42 offen offset:0 sc1
    v_mfma_f32_16x16x32_bf16 v[224:227], a[192:195], a[32:35], v[224:227]
    ds_read_b64_tr_b16 a[152:153], v43 offset:20544
    v_mfma_f32_16x16x32_bf16 v[228:231], a[192:195], a[36:39], v[228:231]
    ds_read_b64_tr_b16 a[154:155], v43 offset:25664
    v_mfma_f32_16x16x32_bf16 v[232:235], a[196:199], a[32:35], v[232:235]
    ds_read_b64_tr_b16 a[156:157], v43 offset:20576
    v_mfma_f32_16x16x32_bf16 v[236:239], a[196:199], a[36:39], v[236:239]
    ds_read_b64_tr_b16 a[158:159], v43 offset:25696
    buffer_store_dwordx4 v[196:199], v47, s[16:19], s42 offen offset:1024 sc1
    v_mfma_f32_16x16x32_bf16 v[240:243], a[200:203], a[32:35], v[240:243]
    ds_read_b64_tr_b16 a[160:161], v43 offset:20608
    v_mfma_f32_16x16x32_bf16 v[244:247], a[200:203], a[36:39], v[244:247]
    ds_read_b64_tr_b16 a[162:163], v43 offset:25728
    s_waitcnt lgkmcnt(10)
    v_mfma_f32_16x16x32_bf16 v[72:75], a[204:207], a[32:35], v[72:75]
    ds_read_b64_tr_b16 a[164:165], v43 offset:20640
    s_add_u32 m0, s38, 40960
    v_mfma_f32_16x16x32_bf16 v[76:79], a[204:207], a[36:39], v[76:79]
    ds_read_b64_tr_b16 a[166:167], v43 offset:25760
    buffer_load_dwordx4 a[0:3], v47, s[16:19], s41 offen offset:0 sc1
    v_mfma_f32_16x16x32_bf16 v[88:91], a[208:211], a[32:35], v[88:91]
    ds_read_b64_tr_b16 a[168:169], v43 offset:20672
    v_mfma_f32_16x16x32_bf16 v[92:95], a[208:211], a[36:39], v[92:95]
    ds_read_b64_tr_b16 a[170:171], v43 offset:25792
    v_mfma_f32_16x16x32_bf16 v[104:107], a[212:215], a[32:35], v[104:107]
    ds_read_b64_tr_b16 a[172:173], v43 offset:20704
    buffer_load_dwordx4 a[4:7], v47, s[16:19], s41 offen offset:1024 sc1
    v_mfma_f32_16x16x32_bf16 v[108:111], a[212:215], a[36:39], v[108:111]
    ds_read_b64_tr_b16 a[174:175], v43 offset:25824
    v_mfma_f32_16x16x32_bf16 v[120:123], a[216:219], a[32:35], v[120:123]
    ds_read_b64_tr_b16 a[176:177], v43 offset:20736
    v_mfma_f32_16x16x32_bf16 v[124:127], a[216:219], a[36:39], v[124:127]
    ds_read_b64_tr_b16 a[178:179], v43 offset:25856
    buffer_load_dwordx4 v15, s[20:23], s74 offen offset:0 lds
    s_waitcnt lgkmcnt(8)
    s_waitcnt vmcnt(17)
    v_mfma_f32_16x16x32_bf16 v[208:211], a[144:147], a[40:43], v[208:211]
    ds_read_b64_tr_b16 a[184:185], v43 offset:30720
    v_mfma_f32_16x16x32_bf16 v[212:215], a[144:147], a[44:47], v[212:215]
    ds_read_b64_tr_b16 a[186:187], v43 offset:35840
    v_mfma_f32_16x16x32_bf16 v[216:219], a[148:151], a[40:43], v[216:219]
    ds_read_b64_tr_b16 a[188:189], v43 offset:30752
    s_add_u32 s41, s83, 8192
    v_mfma_f32_16x16x32_bf16 v[220:223], a[148:151], a[44:47], v[220:223]
    ds_read_b64_tr_b16 a[190:191], v43 offset:35872
    buffer_load_dwordx4 v16, s[20:23], s74 offen offset:1024 lds
    v_mfma_f32_16x16x32_bf16 v[224:227], a[152:155], a[40:43], v[224:227]
    ds_read_b64_tr_b16 a[192:193], v43 offset:30784
    v_mfma_f32_16x16x32_bf16 v[228:231], a[152:155], a[44:47], v[228:231]
    ds_read_b64_tr_b16 a[194:195], v43 offset:35904
    v_mfma_f32_16x16x32_bf16 v[232:235], a[156:159], a[40:43], v[232:235]
    ds_read_b64_tr_b16 a[196:197], v43 offset:30816
    buffer_load_dwordx4 a[8:11], v47, s[16:19], s41 offen offset:0 sc1
    v_mfma_f32_16x16x32_bf16 v[236:239], a[156:159], a[44:47], v[236:239]
    ds_read_b64_tr_b16 a[198:199], v43 offset:35936
    v_mfma_f32_16x16x32_bf16 v[240:243], a[160:163], a[40:43], v[240:243]
    ds_read_b64_tr_b16 a[200:201], v43 offset:30848
    v_mfma_f32_16x16x32_bf16 v[244:247], a[160:163], a[44:47], v[244:247]
    ds_read_b64_tr_b16 a[202:203], v43 offset:35968
    buffer_load_dwordx4 a[12:15], v47, s[16:19], s41 offen offset:1024 sc1
    s_waitcnt lgkmcnt(10)
    v_mfma_f32_16x16x32_bf16 v[72:75], a[164:167], a[40:43], v[72:75]
    ds_read_b64_tr_b16 a[204:205], v43 offset:30880
    v_mfma_f32_16x16x32_bf16 v[76:79], a[164:167], a[44:47], v[76:79]
    ds_read_b64_tr_b16 a[206:207], v43 offset:36000
    v_mfma_f32_16x16x32_bf16 v[88:91], a[168:171], a[40:43], v[88:91]
    ds_read_b64_tr_b16 a[208:209], v43 offset:30912
    buffer_load_dwordx4 v17, s[20:23], s74 offen offset:2048 lds
    v_mfma_f32_16x16x32_bf16 v[92:95], a[168:171], a[44:47], v[92:95]
    ds_read_b64_tr_b16 a[210:211], v43 offset:36032
    v_mfma_f32_16x16x32_bf16 v[104:107], a[172:175], a[40:43], v[104:107]
    ds_read_b64_tr_b16 a[212:213], v43 offset:30944
    v_mfma_f32_16x16x32_bf16 v[108:111], a[172:175], a[44:47], v[108:111]
    ds_read_b64_tr_b16 a[214:215], v43 offset:36064
    v_mfma_f32_16x16x32_bf16 v[120:123], a[176:179], a[40:43], v[120:123]
    ds_read_b64_tr_b16 a[216:217], v43 offset:30976
    buffer_load_dwordx4 v18, s[20:23], s74 offen offset:3072 lds
    s_add_u32 m0, s38, 45056
    v_mfma_f32_16x16x32_bf16 v[124:127], a[176:179], a[44:47], v[124:127]
    ds_read_b64_tr_b16 a[218:219], v43 offset:36096
    s_waitcnt lgkmcnt(8)
    s_waitcnt vmcnt(17)
    v_mfma_f32_16x16x32_bf16 v[208:211], a[184:187], a[48:51], v[208:211]
    s_barrier
    ds_read_b64_tr_b16 a[144:145], v42 offset:0
    v_mfma_f32_16x16x32_bf16 v[212:215], a[184:187], a[52:55], v[212:215]
    ds_read_b64_tr_b16 a[146:147], v42 offset:5120
    buffer_load_dword v51, v49, s[16:19], 0 offen offset:4 sc1
    v_mfma_f32_16x16x32_bf16 v[216:219], a[188:191], a[48:51], v[216:219]
    ds_read_b64_tr_b16 a[148:149], v42 offset:32
    buffer_load_dwordx4 v19, s[20:23], s74 offen lds
    s_add_u32 s41, s83, 16384
    v_mfma_f32_16x16x32_bf16 v[220:223], a[188:191], a[52:55], v[220:223]
    ds_read_b64_tr_b16 a[150:151], v42 offset:5152
    v_mfma_f32_16x16x32_bf16 v[224:227], a[192:195], a[48:51], v[224:227]
    ds_read_b64_tr_b16 a[152:153], v42 offset:64
    v_mfma_f32_16x16x32_bf16 v[228:231], a[192:195], a[52:55], v[228:231]
    ds_read_b64_tr_b16 a[154:155], v42 offset:5184
    v_mfma_f32_16x16x32_bf16 v[232:235], a[196:199], a[48:51], v[232:235]
    ds_read_b64_tr_b16 a[156:157], v42 offset:96
    buffer_load_dwordx4 a[16:19], v47, s[16:19], s41 offen offset:0 sc1
    v_mfma_f32_16x16x32_bf16 v[236:239], a[196:199], a[52:55], v[236:239]
    ds_read_b64_tr_b16 a[158:159], v42 offset:5216
    v_mfma_f32_16x16x32_bf16 v[240:243], a[200:203], a[48:51], v[240:243]
    ds_read_b64_tr_b16 a[160:161], v42 offset:128
    v_mfma_f32_16x16x32_bf16 v[244:247], a[200:203], a[52:55], v[244:247]
    ds_read_b64_tr_b16 a[162:163], v42 offset:5248
    buffer_load_dwordx4 a[20:23], v47, s[16:19], s41 offen offset:1024 sc1
    s_waitcnt lgkmcnt(10)
    v_mfma_f32_16x16x32_bf16 v[72:75], a[204:207], a[48:51], v[72:75]
    ds_read_b64_tr_b16 a[164:165], v42 offset:160
    v_mfma_f32_16x16x32_bf16 v[76:79], a[204:207], a[52:55], v[76:79]
    ds_read_b64_tr_b16 a[166:167], v42 offset:5280
    v_mfma_f32_16x16x32_bf16 v[88:91], a[208:211], a[48:51], v[88:91]
    ds_read_b64_tr_b16 a[168:169], v42 offset:192
    v_mfma_f32_16x16x32_bf16 v[92:95], a[208:211], a[52:55], v[92:95]
    ds_read_b64_tr_b16 a[170:171], v42 offset:5312
    v_mfma_f32_16x16x32_bf16 v[104:107], a[212:215], a[48:51], v[104:107]
    ds_read_b64_tr_b16 a[172:173], v42 offset:224
    v_mfma_f32_16x16x32_bf16 v[108:111], a[212:215], a[52:55], v[108:111]
    ds_read_b64_tr_b16 a[174:175], v42 offset:5344
    v_mfma_f32_16x16x32_bf16 v[120:123], a[216:219], a[48:51], v[120:123]
    ds_read_b64_tr_b16 a[176:177], v42 offset:256
    v_mfma_f32_16x16x32_bf16 v[124:127], a[216:219], a[52:55], v[124:127]
    ds_read_b64_tr_b16 a[178:179], v42 offset:5376
    s_waitcnt lgkmcnt(8)
    s_waitcnt vmcnt(16)
    v_mfma_f32_16x16x32_bf16 v[208:211], a[144:147], a[56:59], v[208:211]
    ds_read_b64_tr_b16 a[184:185], v42 offset:10240
    v_mfma_f32_16x16x32_bf16 v[212:215], a[144:147], a[60:63], v[212:215]
    ds_read_b64_tr_b16 a[186:187], v42 offset:15360
    v_mfma_f32_16x16x32_bf16 v[216:219], a[148:151], a[56:59], v[216:219]
    ds_read_b64_tr_b16 a[188:189], v42 offset:10272
    s_add_u32 s41, s83, 24576
    v_mfma_f32_16x16x32_bf16 v[220:223], a[148:151], a[60:63], v[220:223]
    ds_read_b64_tr_b16 a[190:191], v42 offset:15392
    v_mfma_f32_16x16x32_bf16 v[224:227], a[152:155], a[56:59], v[224:227]
    ds_read_b64_tr_b16 a[192:193], v42 offset:10304
    buffer_load_dwordx4 a[24:27], v47, s[16:19], s41 offen offset:0 sc1
    v_mfma_f32_16x16x32_bf16 v[228:231], a[152:155], a[60:63], v[228:231]
    ds_read_b64_tr_b16 a[194:195], v42 offset:15424
    s_add_u32 m0, s38, 143360
    v_mfma_f32_16x16x32_bf16 v[232:235], a[156:159], a[56:59], v[232:235]
    ds_read_b64_tr_b16 a[196:197], v42 offset:10336
    buffer_load_dwordx4 a[28:31], v47, s[16:19], s41 offen offset:1024 sc1
    v_mfma_f32_16x16x32_bf16 v[236:239], a[156:159], a[60:63], v[236:239]
    ds_read_b64_tr_b16 a[198:199], v42 offset:15456
    v_mfma_f32_16x16x32_bf16 v[240:243], a[160:163], a[56:59], v[240:243]
    ds_read_b64_tr_b16 a[200:201], v42 offset:10368
    v_mfma_f32_16x16x32_bf16 v[244:247], a[160:163], a[60:63], v[244:247]
    ds_read_b64_tr_b16 a[202:203], v42 offset:15488
    buffer_load_dwordx4 v15, s[20:23], s75 offen offset:0 lds
    s_waitcnt lgkmcnt(10)
    v_mfma_f32_16x16x32_bf16 v[72:75], a[164:167], a[56:59], v[72:75]
    ds_read_b64_tr_b16 a[204:205], v42 offset:10400
    v_mfma_f32_16x16x32_bf16 v[76:79], a[164:167], a[60:63], v[76:79]
    ds_read_b64_tr_b16 a[206:207], v42 offset:15520
    v_mfma_f32_16x16x32_bf16 v[88:91], a[168:171], a[56:59], v[88:91]
    ds_read_b64_tr_b16 a[208:209], v42 offset:10432
    v_mfma_f32_16x16x32_bf16 v[92:95], a[168:171], a[60:63], v[92:95]
    ds_read_b64_tr_b16 a[210:211], v42 offset:15552
    buffer_load_dwordx4 v16, s[20:23], s75 offen offset:1024 lds
    v_mfma_f32_16x16x32_bf16 v[104:107], a[172:175], a[56:59], v[104:107]
    ds_read_b64_tr_b16 a[212:213], v42 offset:10464
    v_mfma_f32_16x16x32_bf16 v[108:111], a[172:175], a[60:63], v[108:111]
    ds_read_b64_tr_b16 a[214:215], v42 offset:15584
    v_mfma_f32_16x16x32_bf16 v[120:123], a[176:179], a[56:59], v[120:123]
    ds_read_b64_tr_b16 a[216:217], v42 offset:10496
    buffer_load_dwordx4 v17, s[20:23], s75 offen offset:2048 lds
    v_mfma_f32_16x16x32_bf16 v[124:127], a[176:179], a[60:63], v[124:127]
    ds_read_b64_tr_b16 a[218:219], v42 offset:15616
    s_waitcnt lgkmcnt(8)
    s_waitcnt vmcnt(15)
    v_mfma_f32_16x16x32_bf16 v[208:211], a[184:187], a[0:3], v[208:211]
    s_barrier
    ds_read_b64_tr_b16 a[144:145], v43 offset:40960
    s_waitcnt vmcnt(8)
    v_cmp_ne_u32 vcc, s43, v51
    s_nop 1
    s_cbranch_vccnz L_flag1_3_slow
L_flag1_3_back:
    v_mfma_f32_16x16x32_bf16 v[212:215], a[184:187], a[4:7], v[212:215]
    ds_read_b64_tr_b16 a[146:147], v43 offset:46080
    v_mfma_f32_16x16x32_bf16 v[216:219], a[188:191], a[0:3], v[216:219]
    ds_read_b64_tr_b16 a[148:149], v43 offset:40992
    buffer_load_dwordx4 v18, s[20:23], s75 offen offset:3072 lds
    s_add_u32 m0, s38, 147456
    s_add_u32 s41, s81, 32768
    v_mfma_f32_16x16x32_bf16 v[220:223], a[188:191], a[4:7], v[220:223]
    ds_read_b64_tr_b16 a[150:151], v43 offset:46112
    v_mfma_f32_16x16x32_bf16 v[224:227], a[192:195], a[0:3], v[224:227]
    ds_read_b64_tr_b16 a[152:153], v43 offset:41024
    v_mfma_f32_16x16x32_bf16 v[228:231], a[192:195], a[4:7], v[228:231]
    ds_read_b64_tr_b16 a[154:155], v43 offset:46144
    buffer_load_dwordx4 a[32:35], v47, s[16:19], s41 offen offset:0 sc1
    v_mfma_f32_16x16x32_bf16 v[232:235], a[196:199], a[0:3], v[232:235]
    ds_read_b64_tr_b16 a[156:157], v43 offset:41056
    v_mfma_f32_16x16x32_bf16 v[236:239], a[196:199], a[4:7], v[236:239]
    ds_read_b64_tr_b16 a[158:159], v43 offset:46176
    v_mfma_f32_16x16x32_bf16 v[240:243], a[200:203], a[0:3], v[240:243]
    ds_read_b64_tr_b16 a[160:161], v43 offset:41088
    buffer_load_dwordx4 a[36:39], v47, s[16:19], s41 offen offset:1024 sc1
    s_add_u32 s41, s81, 40960
    v_mfma_f32_16x16x32_bf16 v[244:247], a[200:203], a[4:7], v[244:247]
    ds_read_b64_tr_b16 a[162:163], v43 offset:46208
    s_waitcnt lgkmcnt(10)
    v_mfma_f32_16x16x32_bf16 v[72:75], a[204:207], a[0:3], v[72:75]
    ds_read_b64_tr_b16 a[164:165], v43 offset:41120
    v_mfma_f32_16x16x32_bf16 v[76:79], a[204:207], a[4:7], v[76:79]
    ds_read_b64_tr_b16 a[166:167], v43 offset:46240
    buffer_load_dwordx4 a[40:43], v47, s[16:19], s41 offen offset:0 sc1
    v_mfma_f32_16x16x32_bf16 v[88:91], a[208:211], a[0:3], v[88:91]
    ds_read_b64_tr_b16 a[168:169], v43 offset:41152
    v_mfma_f32_16x16x32_bf16 v[92:95], a[208:211], a[4:7], v[92:95]
    ds_read_b64_tr_b16 a[170:171], v43 offset:46272
    v_mfma_f32_16x16x32_bf16 v[104:107], a[212:215], a[0:3], v[104:107]
    ds_read_b64_tr_b16 a[172:173], v43 offset:41184
    buffer_load_dwordx4 a[44:47], v47, s[16:19], s41 offen offset:1024 sc1
    v_mfma_f32_16x16x32_bf16 v[108:111], a[212:215], a[4:7], v[108:111]
    ds_read_b64_tr_b16 a[174:175], v43 offset:46304
    v_mfma_f32_16x16x32_bf16 v[120:123], a[216:219], a[0:3], v[120:123]
    ds_read_b64_tr_b16 a[176:177], v43 offset:41216
    v_mfma_f32_16x16x32_bf16 v[124:127], a[216:219], a[4:7], v[124:127]
    ds_read_b64_tr_b16 a[178:179], v43 offset:46336
    buffer_load_dwordx4 v19, s[20:23], s75 offen lds
    s_waitcnt lgkmcnt(8)
    v_mfma_f32_16x16x32_bf16 v[208:211], a[144:147], a[8:11], v[208:211]
    ds_read_b64_tr_b16 a[184:185], v43 offset:51200
    v_mfma_f32_16x16x32_bf16 v[212:215], a[144:147], a[12:15], v[212:215]
    ds_read_b64_tr_b16 a[186:187], v43 offset:56320
    v_mfma_f32_16x16x32_bf16 v[216:219], a[148:151], a[8:11], v[216:219]
    ds_read_b64_tr_b16 a[188:189], v43 offset:51232
    s_add_u32 s41, s81, 49152
    v_mfma_f32_16x16x32_bf16 v[220:223], a[148:151], a[12:15], v[220:223]
    ds_read_b64_tr_b16 a[190:191], v43 offset:56352
    v_mfma_f32_16x16x32_bf16 v[224:227], a[152:155], a[8:11], v[224:227]
    ds_read_b64_tr_b16 a[192:193], v43 offset:51264
    buffer_load_dwordx4 a[48:51], v47, s[16:19], s41 offen offset:0 sc1
    v_mfma_f32_16x16x32_bf16 v[228:231], a[152:155], a[12:15], v[228:231]
    ds_read_b64_tr_b16 a[194:195], v43 offset:56384
    v_mfma_f32_16x16x32_bf16 v[232:235], a[156:159], a[8:11], v[232:235]
    ds_read_b64_tr_b16 a[196:197], v43 offset:51296
    buffer_load_dwordx4 a[52:55], v47, s[16:19], s41 offen offset:1024 sc1
    v_mfma_f32_16x16x32_bf16 v[236:239], a[156:159], a[12:15], v[236:239]
    ds_read_b64_tr_b16 a[198:199], v43 offset:56416
    v_mfma_f32_16x16x32_bf16 v[240:243], a[160:163], a[8:11], v[240:243]
    ds_read_b64_tr_b16 a[200:201], v43 offset:51328
    v_mfma_f32_16x16x32_bf16 v[244:247], a[160:163], a[12:15], v[244:247]
    ds_read_b64_tr_b16 a[202:203], v43 offset:56448
    s_waitcnt lgkmcnt(10)
    v_mfma_f32_16x16x32_bf16 v[72:75], a[164:167], a[8:11], v[72:75]
    ds_read_b64_tr_b16 a[204:205], v43 offset:51360
    v_mfma_f32_16x16x32_bf16 v[76:79], a[164:167], a[12:15], v[76:79]
    ds_read_b64_tr_b16 a[206:207], v43 offset:56480
    v_mfma_f32_16x16x32_bf16 v[88:91], a[168:171], a[8:11], v[88:91]
    ds_read_b64_tr_b16 a[208:209], v43 offset:51392
    v_mfma_f32_16x16x32_bf16 v[92:95], a[168:171], a[12:15], v[92:95]
    ds_read_b64_tr_b16 a[210:211], v43 offset:56512
    v_mfma_f32_16x16x32_bf16 v[104:107], a[172:175], a[8:11], v[104:107]
    ds_read_b64_tr_b16 a[212:213], v43 offset:51424
    v_mfma_f32_16x16x32_bf16 v[108:111], a[172:175], a[12:15], v[108:111]
    ds_read_b64_tr_b16 a[214:215], v43 offset:56544
    v_mfma_f32_16x16x32_bf16 v[120:123], a[176:179], a[8:11], v[120:123]
    ds_read_b64_tr_b16 a[216:217], v43 offset:51456
    v_mfma_f32_16x16x32_bf16 v[124:127], a[176:179], a[12:15], v[124:127]
    ds_read_b64_tr_b16 a[218:219], v43 offset:56576
    s_waitcnt lgkmcnt(8)
    s_waitcnt vmcnt(13)
    v_mfma_f32_16x16x32_bf16 v[208:211], a[184:187], a[16:19], v[208:211]
    s_barrier
    ds_read_b64_tr_b16 a[144:145], v42 offset:20480
    s_add_u32 m0, s38, 61440
    v_mfma_f32_16x16x32_bf16 v[212:215], a[184:187], a[20:23], v[212:215]
    ds_read_b64_tr_b16 a[146:147], v42 offset:25600
    buffer_load_dwordx4 v15, s[20:23], s76 offen offset:0 lds
    v_mfma_f32_16x16x32_bf16 v[216:219], a[188:191], a[16:19], v[216:219]
    ds_read_b64_tr_b16 a[148:149], v42 offset:20512
    v_mfma_f32_16x16x32_bf16 v[220:223], a[188:191], a[20:23], v[220:223]
    ds_read_b64_tr_b16 a[150:151], v42 offset:25632
    v_mfma_f32_16x16x32_bf16 v[224:227], a[192:195], a[16:19], v[224:227]
    ds_read_b64_tr_b16 a[152:153], v42 offset:20544
    buffer_store_dword v52, v50, s[16:19], 0 offen offset:8 sc1
    v_mfma_f32_16x16x32_bf16 v[228:231], a[192:195], a[20:23], v[228:231]
    ds_read_b64_tr_b16 a[154:155], v42 offset:25664
    buffer_load_dwordx4 v16, s[20:23], s76 offen offset:1024 lds
    v_mfma_f32_16x16x32_bf16 v[232:235], a[196:199], a[16:19], v[232:235]
    ds_read_b64_tr_b16 a[156:157], v42 offset:20576
    v_mfma_f32_16x16x32_bf16 v[236:239], a[196:199], a[20:23], v[236:239]
    ds_read_b64_tr_b16 a[158:159], v42 offset:25696
    v_mfma_f32_16x16x32_bf16 v[240:243], a[200:203], a[16:19], v[240:243]
    ds_read_b64_tr_b16 a[160:161], v42 offset:20608
    buffer_load_dwordx4 v17, s[20:23], s76 offen offset:2048 lds
    v_mfma_f32_16x16x32_bf16 v[244:247], a[200:203], a[20:23], v[244:247]
    ds_read_b64_tr_b16 a[162:163], v42 offset:25728
    s_waitcnt lgkmcnt(10)
    v_mfma_f32_16x16x32_bf16 v[72:75], a[204:207], a[16:19], v[72:75]
    ds_read_b64_tr_b16 a[164:165], v42 offset:20640
    v_mfma_f32_16x16x32_bf16 v[76:79], a[204:207], a[20:23], v[76:79]
    ds_read_b64_tr_b16 a[166:167], v42 offset:25760
    buffer_load_dwordx4 v18, s[20:23], s76 offen offset:3072 lds
    s_add_u32 m0, s38, 65536
    v_mfma_f32_16x16x32_bf16 v[88:91], a[208:211], a[16:19], v[88:91]
    ds_read_b64_tr_b16 a[168:169], v42 offset:20672
    v_mfma_f32_16x16x32_bf16 v[92:95], a[208:211], a[20:23], v[92:95]
    ds_read_b64_tr_b16 a[170:171], v42 offset:25792
    v_mfma_f32_16x16x32_bf16 v[104:107], a[212:215], a[16:19], v[104:107]
    ds_read_b64_tr_b16 a[172:173], v42 offset:20704
    v_mfma_f32_16x16x32_bf16 v[108:111], a[212:215], a[20:23], v[108:111]
    ds_read_b64_tr_b16 a[174:175], v42 offset:25824
    buffer_load_dwordx4 v19, s[20:23], s76 offen lds
    v_mfma_f32_16x16x32_bf16 v[120:123], a[216:219], a[16:19], v[120:123]
    ds_read_b64_tr_b16 a[176:177], v42 offset:20736
    v_mfma_f32_16x16x32_bf16 v[124:127], a[216:219], a[20:23], v[124:127]
    ds_read_b64_tr_b16 a[178:179], v42 offset:25856
    s_waitcnt lgkmcnt(8)
    s_waitcnt vmcnt(17)
    v_mfma_f32_16x16x32_bf16 v[208:211], a[144:147], a[24:27], v[208:211]
    ds_read_b64_tr_b16 a[184:185], v42 offset:30720
    v_mfma_f32_16x16x32_bf16 v[212:215], a[144:147], a[28:31], v[212:215]
    ds_read_b64_tr_b16 a[186:187], v42 offset:35840
    v_mfma_f32_16x16x32_bf16 v[216:219], a[148:151], a[24:27], v[216:219]
    ds_read_b64_tr_b16 a[188:189], v42 offset:30752
    s_add_u32 s41, s82, 32768
    v_mfma_f32_16x16x32_bf16 v[220:223], a[148:151], a[28:31], v[220:223]
    ds_read_b64_tr_b16 a[190:191], v42 offset:35872
    v_mfma_f32_16x16x32_bf16 v[224:227], a[152:155], a[24:27], v[224:227]
    ds_read_b64_tr_b16 a[192:193], v42 offset:30784
    buffer_load_dwordx4 a[56:59], v47, s[16:19], s41 offen offset:0 sc1
    v_mfma_f32_16x16x32_bf16 v[228:231], a[152:155], a[28:31], v[228:231]
    ds_read_b64_tr_b16 a[194:195], v42 offset:35904
    v_mfma_f32_16x16x32_bf16 v[232:235], a[156:159], a[24:27], v[232:235]
    ds_read_b64_tr_b16 a[196:197], v42 offset:30816
    buffer_load_dwordx4 a[60:63], v47, s[16:19], s41 offen offset:1024 sc1
    v_mfma_f32_16x16x32_bf16 v[236:239], a[156:159], a[28:31], v[236:239]
    ds_read_b64_tr_b16 a[198:199], v42 offset:35936
    v_mfma_f32_16x16x32_bf16 v[240:243], a[160:163], a[24:27], v[240:243]
    ds_read_b64_tr_b16 a[200:201], v42 offset:30848
    v_mfma_f32_16x16x32_bf16 v[244:247], a[160:163], a[28:31], v[244:247]
    ds_read_b64_tr_b16 a[202:203], v42 offset:35968
    s_waitcnt lgkmcnt(10)
    v_mfma_f32_16x16x32_bf16 v[72:75], a[164:167], a[24:27], v[72:75]
    ds_read_b64_tr_b16 a[204:205], v42 offset:30880
    v_mfma_f32_16x16x32_bf16 v[76:79], a[164:167], a[28:31], v[76:79]
    ds_read_b64_tr_b16 a[206:207], v42 offset:36000
    v_mfma_f32_16x16x32_bf16 v[88:91], a[168:171], a[24:27], v[88:91]
    ds_read_b64_tr_b16 a[208:209], v42 offset:30912
    v_mfma_f32_16x16x32_bf16 v[92:95], a[168:171], a[28:31], v[92:95]
    ds_read_b64_tr_b16 a[210:211], v42 offset:36032
    v_mfma_f32_16x16x32_bf16 v[104:107], a[172:175], a[24:27], v[104:107]
    ds_read_b64_tr_b16 a[212:213], v42 offset:30944
    v_mfma_f32_16x16x32_bf16 v[108:111], a[172:175], a[28:31], v[108:111]
    ds_read_b64_tr_b16 a[214:215], v42 offset:36064
    v_mfma_f32_16x16x32_bf16 v[120:123], a[176:179], a[24:27], v[120:123]
    ds_read_b64_tr_b16 a[216:217], v42 offset:30976
    v_mfma_f32_16x16x32_bf16 v[124:127], a[176:179], a[28:31], v[124:127]
    ds_read_b64_tr_b16 a[218:219], v42 offset:36096
    s_waitcnt lgkmcnt(8)
    s_waitcnt vmcnt(13)
    v_mfma_f32_16x16x32_bf16 v[208:211], a[184:187], a[32:35], v[208:211]
    s_barrier
    ds_read_b64_tr_b16 a[144:145], v44 offset:0
    v_mfma_f32_16x16x32_bf16 v[212:215], a[184:187], a[36:39], v[212:215]
    ds_read_b64_tr_b16 a[146:147], v44 offset:5120
    v_mfma_f32_16x16x32_bf16 v[216:219], a[188:191], a[32:35], v[216:219]
    ds_read_b64_tr_b16 a[148:149], v44 offset:32
    s_add_u32 s41, s82, 40960
    v_mfma_f32_16x16x32_bf16 v[220:223], a[188:191], a[36:39], v[220:223]
    ds_read_b64_tr_b16 a[150:151], v44 offset:5152
    v_mfma_f32_16x16x32_bf16 v[224:227], a[192:195], a[32:35], v[224:227]
    ds_read_b64_tr_b16 a[152:153], v44 offset:64
    buffer_load_dwordx4 a[0:3], v47, s[16:19], s41 offen offset:0 sc1
    v_mfma_f32_16x16x32_bf16 v[228:231], a[192:195], a[36:39], v[228:231]
    ds_read_b64_tr_b16 a[154:155], v44 offset:5184
    v_mfma_f32_16x16x32_bf16 v[232:235], a[196:199], a[32:35], v[232:235]
    ds_read_b64_tr_b16 a[156:157], v44 offset:96
    buffer_load_dwordx4 a[4:7], v47, s[16:19], s41 offen offset:1024 sc1
    v_mfma_f32_16x16x32_bf16 v[236:239], a[196:199], a[36:39], v[236:239]
    ds_read_b64_tr_b16 a[158:159], v44 offset:5216
    v_mfma_f32_16x16x32_bf16 v[240:243], a[200:203], a[32:35], v[240:243]
    ds_read_b64_tr_b16 a[160:161], v44 offset:128
    v_mfma_f32_16x16x32_bf16 v[244:247], a[200:203], a[36:39], v[244:247]
    ds_read_b64_tr_b16 a[162:163], v44 offset:5248
    s_waitcnt lgkmcnt(10)
    v_mfma_f32_16x16x32_bf16 v[72:75], a[204:207], a[32:35], v[72:75]
    ds_read_b64_tr_b16 a[164:165], v44 offset:160
    v_mfma_f32_16x16x32_bf16 v[76:79], a[204:207], a[36:39], v[76:79]
    ds_read_b64_tr_b16 a[166:167], v44 offset:5280
    v_mfma_f32_16x16x32_bf16 v[88:91], a[208:211], a[32:35], v[88:91]
    ds_read_b64_tr_b16 a[168:169], v44 offset:192
    v_mfma_f32_16x16x32_bf16 v[92:95], a[208:211], a[36:39], v[92:95]
    ds_read_b64_tr_b16 a[170:171], v44 offset:5312
    s_add_u32 m0, s38, 81920
    v_mfma_f32_16x16x32_bf16 v[104:107], a[212:215], a[32:35], v[104:107]
    ds_read_b64_tr_b16 a[172:173], v44 offset:224
    buffer_load_dwordx4 v15, s[20:23], s77 offen offset:0 lds
    v_mfma_f32_16x16x32_bf16 v[108:111], a[212:215], a[36:39], v[108:111]
    ds_read_b64_tr_b16 a[174:175], v44 offset:5344
    v_mfma_f32_16x16x32_bf16 v[120:123], a[216:219], a[32:35], v[120:123]
    ds_read_b64_tr_b16 a[176:177], v44 offset:256
    v_mfma_f32_16x16x32_bf16 v[124:127], a[216:219], a[36:39], v[124:127]
    ds_read_b64_tr_b16 a[178:179], v44 offset:5376
    buffer_load_dwordx4 v16, s[20:23], s77 offen offset:1024 lds
    s_waitcnt lgkmcnt(8)
    s_waitcnt vmcnt(15)
    v_mfma_f32_16x16x32_bf16 v[208:211], a[144:147], a[40:43], v[208:211]
    ds_read_b64_tr_b16 a[184:185], v44 offset:10240
    v_mfma_f32_16x16x32_bf16 v[212:215], a[144:147], a[44:47], v[212:215]
    ds_read_b64_tr_b16 a[186:187], v44 offset:15360
    v_mfma_f32_16x16x32_bf16 v[216:219], a[148:151], a[40:43], v[216:219]
    ds_read_b64_tr_b16 a[188:189], v44 offset:10272
    buffer_load_dwordx4 v17, s[20:23], s77 offen offset:2048 lds
    s_add_u32 s41, s82, 49152
    v_mfma_f32_16x16x32_bf16 v[220:223], a[148:151], a[44:47], v[220:223]
    ds_read_b64_tr_b16 a[190:191], v44 offset:15392
    v_mfma_f32_16x16x32_bf16 v[224:227], a[152:155], a[40:43], v[224:227]
    ds_read_b64_tr_b16 a[192:193], v44 offset:10304
    v_mfma_f32_16x16x32_bf16 v[228:231], a[152:155], a[44:47], v[228:231]
    ds_read_b64_tr_b16 a[194:195], v44 offset:15424
    v_mfma_f32_16x16x32_bf16 v[232:235], a[156:159], a[40:43], v[232:235]
    ds_read_b64_tr_b16 a[196:197], v44 offset:10336
    buffer_load_dwordx4 a[8:11], v47, s[16:19], s41 offen offset:0 sc1
    v_mfma_f32_16x16x32_bf16 v[236:239], a[156:159], a[44:47], v[236:239]
    ds_read_b64_tr_b16 a[198:199], v44 offset:15456
    v_mfma_f32_16x16x32_bf16 v[240:243], a[160:163], a[40:43], v[240:243]
    ds_read_b64_tr_b16 a[200:201], v44 offset:10368
    v_mfma_f32_16x16x32_bf16 v[244:247], a[160:163], a[44:47], v[244:247]
    ds_read_b64_tr_b16 a[202:203], v44 offset:15488
    buffer_load_dwordx4 a[12:15], v47, s[16:19], s41 offen offset:1024 sc1
    s_waitcnt lgkmcnt(10)
    v_mfma_f32_16x16x32_bf16 v[72:75], a[164:167], a[40:43], v[72:75]
    ds_read_b64_tr_b16 a[204:205], v44 offset:10400
    v_mfma_f32_16x16x32_bf16 v[76:79], a[164:167], a[44:47], v[76:79]
    ds_read_b64_tr_b16 a[206:207], v44 offset:15520
    v_mfma_f32_16x16x32_bf16 v[88:91], a[168:171], a[40:43], v[88:91]
    ds_read_b64_tr_b16 a[208:209], v44 offset:10432
    buffer_load_dwordx4 v18, s[20:23], s77 offen offset:3072 lds
    s_add_u32 m0, s38, 86016
    v_mfma_f32_16x16x32_bf16 v[92:95], a[168:171], a[44:47], v[92:95]
    ds_read_b64_tr_b16 a[210:211], v44 offset:15552
    v_mfma_f32_16x16x32_bf16 v[104:107], a[172:175], a[40:43], v[104:107]
    ds_read_b64_tr_b16 a[212:213], v44 offset:10464
    v_mfma_f32_16x16x32_bf16 v[108:111], a[172:175], a[44:47], v[108:111]
    ds_read_b64_tr_b16 a[214:215], v44 offset:15584
    buffer_load_dwordx4 v19, s[20:23], s77 offen lds
    v_mfma_f32_16x16x32_bf16 v[120:123], a[176:179], a[40:43], v[120:123]
    ds_read_b64_tr_b16 a[216:217], v44 offset:10496
    v_mfma_f32_16x16x32_bf16 v[124:127], a[176:179], a[44:47], v[124:127]
    ds_read_b64_tr_b16 a[218:219], v44 offset:15616
    s_waitcnt lgkmcnt(8)
    s_waitcnt vmcnt(17)
    v_mfma_f32_16x16x32_bf16 v[208:211], a[184:187], a[48:51], v[208:211]
    s_barrier
    ds_read_b64_tr_b16 a[144:145], v42 offset:40960
    v_mfma_f32_16x16x32_bf16 v[212:215], a[184:187], a[52:55], v[212:215]
    ds_read_b64_tr_b16 a[146:147], v42 offset:46080
    buffer_load_dword v51, v49, s[16:19], 0 offen offset:8 sc1
    v_mfma_f32_16x16x32_bf16 v[216:219], a[188:191], a[48:51], v[216:219]
    ds_read_b64_tr_b16 a[148:149], v42 offset:40992
    s_add_u32 s41, s83, 32768
    v_mfma_f32_16x16x32_bf16 v[220:223], a[188:191], a[52:55], v[220:223]
    ds_read_b64_tr_b16 a[150:151], v42 offset:46112
    v_mfma_f32_16x16x32_bf16 v[224:227], a[192:195], a[48:51], v[224:227]
    ds_read_b64_tr_b16 a[152:153], v42 offset:41024
    buffer_load_dwordx4 a[16:19], v47, s[16:19], s41 offen offset:0 sc1
    v_mfma_f32_16x16x32_bf16 v[228:231], a[192:195], a[52:55], v[228:231]
    ds_read_b64_tr_b16 a[154:155], v42 offset:46144
    v_mfma_f32_16x16x32_bf16 v[232:235], a[196:199], a[48:51], v[232:235]
    ds_read_b64_tr_b16 a[156:157], v42 offset:41056
    buffer_load_dwordx4 a[20:23], v47, s[16:19], s41 offen offset:1024 sc1
    v_mfma_f32_16x16x32_bf16 v[236:239], a[196:199], a[52:55], v[236:239]
    ds_read_b64_tr_b16 a[158:159], v42 offset:46176
    v_mfma_f32_16x16x32_bf16 v[240:243], a[200:203], a[48:51], v[240:243]
    ds_read_b64_tr_b16 a[160:161], v42 offset:41088
    v_mfma_f32_16x16x32_bf16 v[244:247], a[200:203], a[52:55], v[244:247]
    ds_read_b64_tr_b16 a[162:163], v42 offset:46208
    s_waitcnt lgkmcnt(10)
    v_mfma_f32_16x16x32_bf16 v[72:75], a[204:207], a[48:51], v[72:75]
    ds_read_b64_tr_b16 a[164:165], v42 offset:41120
    v_mfma_f32_16x16x32_bf16 v[76:79], a[204:207], a[52:55], v[76:79]
    ds_read_b64_tr_b16 a[166:167], v42 offset:46240
    v_mfma_f32_16x16x32_bf16 v[88:91], a[208:211], a[48:51], v[88:91]
    ds_read_b64_tr_b16 a[168:169], v42 offset:41152
    v_mfma_f32_16x16x32_bf16 v[92:95], a[208:211], a[52:55], v[92:95]
    ds_read_b64_tr_b16 a[170:171], v42 offset:46272
    v_mfma_f32_16x16x32_bf16 v[104:107], a[212:215], a[48:51], v[104:107]
    ds_read_b64_tr_b16 a[172:173], v42 offset:41184
    v_mfma_f32_16x16x32_bf16 v[108:111], a[212:215], a[52:55], v[108:111]
    ds_read_b64_tr_b16 a[174:175], v42 offset:46304
    v_mfma_f32_16x16x32_bf16 v[120:123], a[216:219], a[48:51], v[120:123]
    ds_read_b64_tr_b16 a[176:177], v42 offset:41216
    v_mfma_f32_16x16x32_bf16 v[124:127], a[216:219], a[52:55], v[124:127]
    ds_read_b64_tr_b16 a[178:179], v42 offset:46336
    s_waitcnt lgkmcnt(8)
    s_waitcnt vmcnt(12)
    v_mfma_f32_16x16x32_bf16 v[208:211], a[144:147], a[56:59], v[208:211]
    ds_read_b64_tr_b16 a[184:185], v42 offset:51200
    v_mfma_f32_16x16x32_bf16 v[212:215], a[144:147], a[60:63], v[212:215]
    ds_read_b64_tr_b16 a[186:187], v42 offset:56320
    v_mfma_f32_16x16x32_bf16 v[216:219], a[148:151], a[56:59], v[216:219]
    ds_read_b64_tr_b16 a[188:189], v42 offset:51232
    s_add_u32 s41, s83, 40960
    v_mfma_f32_16x16x32_bf16 v[220:223], a[148:151], a[60:63], v[220:223]
    ds_read_b64_tr_b16 a[190:191], v42 offset:56352
    v_mfma_f32_16x16x32_bf16 v[224:227], a[152:155], a[56:59], v[224:227]
    ds_read_b64_tr_b16 a[192:193], v42 offset:51264
    buffer_load_dwordx4 a[24:27], v47, s[16:19], s41 offen offset:0 sc1
    v_mfma_f32_16x16x32_bf16 v[228:231], a[152:155], a[60:63], v[228:231]
    ds_read_b64_tr_b16 a[194:195], v42 offset:56384
    v_mfma_f32_16x16x32_bf16 v[232:235], a[156:159], a[56:59], v[232:235]
    ds_read_b64_tr_b16 a[196:197], v42 offset:51296
    buffer_load_dwordx4 a[28:31], v47, s[16:19], s41 offen offset:1024 sc1
    v_mfma_f32_16x16x32_bf16 v[236:239], a[156:159], a[60:63], v[236:239]
    ds_read_b64_tr_b16 a[198:199], v42 offset:56416
    v_mfma_f32_16x16x32_bf16 v[240:243], a[160:163], a[56:59], v[240:243]
    ds_read_b64_tr_b16 a[200:201], v42 offset:51328
    s_add_u32 m0, s38, 0
    v_mfma_f32_16x16x32_bf16 v[244:247], a[160:163], a[60:63], v[244:247]
    ds_read_b64_tr_b16 a[202:203], v42 offset:56448
    buffer_load_dwordx4 v15, s[20:23], s78 offen offset:0 lds
    s_waitcnt lgkmcnt(10)
    v_mfma_f32_16x16x32_bf16 v[72:75], a[164:167], a[56:59], v[72:75]
    ds_read_b64_tr_b16 a[204:205], v42 offset:51360
    v_mfma_f32_16x16x32_bf16 v[76:79], a[164:167], a[60:63], v[76:79]
    ds_read_b64_tr_b16 a[206:207], v42 offset:56480
    v_mfma_f32_16x16x32_bf16 v[88:91], a[168:171], a[56:59], v[88:91]
    ds_read_b64_tr_b16 a[208:209], v42 offset:51392
    v_mfma_f32_16x16x32_bf16 v[92:95], a[168:171], a[60:63], v[92:95]
    ds_read_b64_tr_b16 a[210:211], v42 offset:56512
    buffer_load_dwordx4 v16, s[20:23], s78 offen offset:1024 lds
    v_mfma_f32_16x16x32_bf16 v[104:107], a[172:175], a[56:59], v[104:107]
    ds_read_b64_tr_b16 a[212:213], v42 offset:51424
    v_mfma_f32_16x16x32_bf16 v[108:111], a[172:175], a[60:63], v[108:111]
    ds_read_b64_tr_b16 a[214:215], v42 offset:56544
    v_mfma_f32_16x16x32_bf16 v[120:123], a[176:179], a[56:59], v[120:123]
    ds_read_b64_tr_b16 a[216:217], v42 offset:51456
    buffer_load_dwordx4 v17, s[20:23], s78 offen offset:2048 lds
    v_mfma_f32_16x16x32_bf16 v[124:127], a[176:179], a[60:63], v[124:127]
    ds_read_b64_tr_b16 a[218:219], v42 offset:56576
    s_waitcnt lgkmcnt(8)
    s_waitcnt vmcnt(15)
    v_mfma_f32_16x16x32_bf16 v[208:211], a[184:187], a[0:3], v[208:211]
    s_barrier
    ds_read_b64_tr_b16 a[144:145], v44 offset:20480
    s_waitcnt vmcnt(7)
    v_cmp_ne_u32 vcc, s43, v51
    s_nop 1
    s_cbranch_vccnz L_flag2_4_slow
L_flag2_4_back:
    v_mfma_f32_16x16x32_bf16 v[212:215], a[184:187], a[4:7], v[212:215]
    ds_read_b64_tr_b16 a[146:147], v44 offset:25600
    v_mfma_f32_16x16x32_bf16 v[216:219], a[188:191], a[0:3], v[216:219]
    ds_read_b64_tr_b16 a[148:149], v44 offset:20512
    buffer_load_dwordx4 v18, s[20:23], s78 offen offset:3072 lds
    s_add_u32 m0, s38, 4096
    s_add_u32 s41, s83, 49152
    v_mfma_f32_16x16x32_bf16 v[220:223], a[188:191], a[4:7], v[220:223]
    ds_read_b64_tr_b16 a[150:151], v44 offset:25632
    v_mfma_f32_16x16x32_bf16 v[224:227], a[192:195], a[0:3], v[224:227]
    ds_read_b64_tr_b16 a[152:153], v44 offset:20544
    v_mfma_f32_16x16x32_bf16 v[228:231], a[192:195], a[4:7], v[228:231]
    ds_read_b64_tr_b16 a[154:155], v44 offset:25664
    buffer_load_dwordx4 a[32:35], v47, s[16:19], s41 offen offset:0 sc1
    v_mfma_f32_16x16x32_bf16 v[232:235], a[196:199], a[0:3], v[232:235]
    ds_read_b64_tr_b16 a[156:157], v44 offset:20576
    v_mfma_f32_16x16x32_bf16 v[236:239], a[196:199], a[4:7], v[236:239]
    ds_read_b64_tr_b16 a[158:159], v44 offset:25696
    v_mfma_f32_16x16x32_bf16 v[240:243], a[200:203], a[0:3], v[240:243]
    ds_read_b64_tr_b16 a[160:161], v44 offset:20608
    buffer_load_dwordx4 a[36:39], v47, s[16:19], s41 offen offset:1024 sc1
    s_add_u32 s41, s81, 57344
    v_mfma_f32_16x16x32_bf16 v[244:247], a[200:203], a[4:7], v[244:247]
    ds_read_b64_tr_b16 a[162:163], v44 offset:25728
    s_waitcnt lgkmcnt(10)
    v_mfma_f32_16x16x32_bf16 v[72:75], a[204:207], a[0:3], v[72:75]
    ds_read_b64_tr_b16 a[164:165], v44 offset:20640
    v_mfma_f32_16x16x32_bf16 v[76:79], a[204:207], a[4:7], v[76:79]
    ds_read_b64_tr_b16 a[166:167], v44 offset:25760
    buffer_load_dwordx4 a[40:43], v47, s[16:19], s41 offen offset:0 sc1
    v_mfma_f32_16x16x32_bf16 v[88:91], a[208:211], a[0:3], v[88:91]
    ds_read_b64_tr_b16 a[168:169], v44 offset:20672
    v_mfma_f32_16x16x32_bf16 v[92:95], a[208:211], a[4:7], v[92:95]
    ds_read_b64_tr_b16 a[170:171], v44 offset:25792
    v_mfma_f32_16x16x32_bf16 v[104:107], a[212:215], a[0:3], v[104:107]
    ds_read_b64_tr_b16 a[172:173], v44 offset:20704
    buffer_load_dwordx4 a[44:47], v47, s[16:19], s41 offen offset:1024 sc1
    v_mfma_f32_16x16x32_bf16 v[108:111], a[212:215], a[4:7], v[108:111]
    ds_read_b64_tr_b16 a[174:175], v44 offset:25824
    v_mfma_f32_16x16x32_bf16 v[120:123], a[216:219], a[0:3], v[120:123]
    ds_read_b64_tr_b16 a[176:177], v44 offset:20736
    v_mfma_f32_16x16x32_bf16 v[124:127], a[216:219], a[4:7], v[124:127]
    ds_read_b64_tr_b16 a[178:179], v44 offset:25856
    buffer_load_dwordx4 v19, s[20:23], s78 offen lds
    s_waitcnt lgkmcnt(8)
    v_mfma_f32_16x16x32_bf16 v[208:211], a[144:147], a[8:11], v[208:211]
    ds_read_b64_tr_b16 a[184:185], v44 offset:30720
    v_mfma_f32_16x16x32_bf16 v[212:215], a[144:147], a[12:15], v[212:215]
    ds_read_b64_tr_b16 a[186:187], v44 offset:35840
    v_mfma_f32_16x16x32_bf16 v[216:219], a[148:151], a[8:11], v[216:219]
    ds_read_b64_tr_b16 a[188:189], v44 offset:30752
    s_add_u32 s41, s81, 65536
    v_mfma_f32_16x16x32_bf16 v[220:223], a[148:151], a[12:15], v[220:223]
    ds_read_b64_tr_b16 a[190:191], v44 offset:35872
    v_mfma_f32_16x16x32_bf16 v[224:227], a[152:155], a[8:11], v[224:227]
    ds_read_b64_tr_b16 a[192:193], v44 offset:30784
    buffer_load_dwordx4 a[48:51], v47, s[16:19], s41 offen offset:0 sc1
    v_mfma_f32_16x16x32_bf16 v[228:231], a[152:155], a[12:15], v[228:231]
    ds_read_b64_tr_b16 a[194:195], v44 offset:35904
    v_mfma_f32_16x16x32_bf16 v[232:235], a[156:159], a[8:11], v[232:235]
    ds_read_b64_tr_b16 a[196:197], v44 offset:30816
    buffer_load_dwordx4 a[52:55], v47, s[16:19], s41 offen offset:1024 sc1
    v_mfma_f32_16x16x32_bf16 v[236:239], a[156:159], a[12:15], v[236:239]
    ds_read_b64_tr_b16 a[198:199], v44 offset:35936
    v_mfma_f32_16x16x32_bf16 v[240:243], a[160:163], a[8:11], v[240:243]
    ds_read_b64_tr_b16 a[200:201], v44 offset:30848
    v_mfma_f32_16x16x32_bf16 v[244:247], a[160:163], a[12:15], v[244:247]
    ds_read_b64_tr_b16 a[202:203], v44 offset:35968
    s_waitcnt lgkmcnt(10)
    v_mfma_f32_16x16x32_bf16 v[72:75], a[164:167], a[8:11], v[72:75]
    ds_read_b64_tr_b16 a[204:205], v44 offset:30880
    v_mfma_f32_16x16x32_bf16 v[76:79], a[164:167], a[12:15], v[76:79]
    ds_read_b64_tr_b16 a[206:207], v44 offset:36000
    v_mfma_f32_16x16x32_bf16 v[88:91], a[168:171], a[8:11], v[88:91]
    ds_read_b64_tr_b16 a[208:209], v44 offset:30912
    v_mfma_f32_16x16x32_bf16 v[92:95], a[168:171], a[12:15], v[92:95]
    ds_read_b64_tr_b16 a[210:211], v44 offset:36032
    v_mfma_f32_16x16x32_bf16 v[104:107], a[172:175], a[8:11], v[104:107]
    ds_read_b64_tr_b16 a[212:213], v44 offset:30944
    v_mfma_f32_16x16x32_bf16 v[108:111], a[172:175], a[12:15], v[108:111]
    ds_read_b64_tr_b16 a[214:215], v44 offset:36064
    v_mfma_f32_16x16x32_bf16 v[120:123], a[176:179], a[8:11], v[120:123]
    ds_read_b64_tr_b16 a[216:217], v44 offset:30976
    v_mfma_f32_16x16x32_bf16 v[124:127], a[176:179], a[12:15], v[124:127]
    ds_read_b64_tr_b16 a[218:219], v44 offset:36096
    s_waitcnt lgkmcnt(8)
    s_waitcnt vmcnt(13)
    v_mfma_f32_16x16x32_bf16 v[208:211], a[184:187], a[16:19], v[208:211]
    s_barrier
    ds_read_b64_tr_b16 a[144:145], v43 offset:0
    v_mfma_f32_16x16x32_bf16 v[212:215], a[184:187], a[20:23], v[212:215]
    ds_read_b64_tr_b16 a[146:147], v43 offset:5120
    v_mfma_f32_16x16x32_bf16 v[216:219], a[188:191], a[16:19], v[216:219]
    ds_read_b64_tr_b16 a[148:149], v43 offset:32
    s_add_u32 s41, s82, 57344
    v_mfma_f32_16x16x32_bf16 v[220:223], a[188:191], a[20:23], v[220:223]
    ds_read_b64_tr_b16 a[150:151], v43 offset:5152
    s_add_u32 m0, s38, 102400
    v_mfma_f32_16x16x32_bf16 v[224:227], a[192:195], a[16:19], v[224:227]
    ds_read_b64_tr_b16 a[152:153], v43 offset:64
    buffer_load_dwordx4 a[56:59], v47, s[16:19], s41 offen offset:0 sc1
    v_mfma_f32_16x16x32_bf16 v[228:231], a[192:195], a[20:23], v[228:231]
    ds_read_b64_tr_b16 a[154:155], v43 offset:5184
    v_mfma_f32_16x16x32_bf16 v[232:235], a[196:199], a[16:19], v[232:235]
    ds_read_b64_tr_b16 a[156:157], v43 offset:96
    buffer_load_dwordx4 v15, s[20:23], s79 offen offset:0 lds
    v_mfma_f32_16x16x32_bf16 v[236:239], a[196:199], a[20:23], v[236:239]
    ds_read_b64_tr_b16 a[158:159], v43 offset:5216
    v_mfma_f32_16x16x32_bf16 v[240:243], a[200:203], a[16:19], v[240:243]
    ds_read_b64_tr_b16 a[160:161], v43 offset:128
    v_mfma_f32_16x16x32_bf16 v[244:247], a[200:203], a[20:23], v[244:247]
    ds_read_b64_tr_b16 a[162:163], v43 offset:5248
    s_waitcnt lgkmcnt(10)
    v_mfma_f32_16x16x32_bf16 v[72:75], a[204:207], a[16:19], v[72:75]
    ds_read_b64_tr_b16 a[164:165], v43 offset:160
    buffer_load_dwordx4 a[60:63], v47, s[16:19], s41 offen offset:1024 sc1
    v_mfma_f32_16x16x32_bf16 v[76:79], a[204:207], a[20:23], v[76:79]
    ds_read_b64_tr_b16 a[166:167], v43 offset:5280
    v_mfma_f32_16x16x32_bf16 v[88:91], a[208:211], a[16:19], v[88:91]
    ds_read_b64_tr_b16 a[168:169], v43 offset:192
    v_mfma_f32_16x16x32_bf16 v[92:95], a[208:211], a[20:23], v[92:95]
    ds_read_b64_tr_b16 a[170:171], v43 offset:5312
    buffer_load_dwordx4 v16, s[20:23], s79 offen offset:1024 lds
    v_mfma_f32_16x16x32_bf16 v[104:107], a[212:215], a[16:19], v[104:107]
    ds_read_b64_tr_b16 a[172:173], v43 offset:224
    v_mfma_f32_16x16x32_bf16 v[108:111], a[212:215], a[20:23], v[108:111]
    ds_read_b64_tr_b16 a[174:175], v43 offset:5344
    v_mfma_f32_16x16x32_bf16 v[120:123], a[216:219], a[16:19], v[120:123]
    ds_read_b64_tr_b16 a[176:177], v43 offset:256
    buffer_load_dwordx4 v17, s[20:23], s79 offen offset:2048 lds
    v_mfma_f32_16x16x32_bf16 v[124:127], a[216:219], a[20:23], v[124:127]
    ds_read_b64_tr_b16 a[178:179], v43 offset:5376
    s_waitcnt lgkmcnt(8)
    s_waitcnt vmcnt(16)
    v_mfma_f32_16x16x32_bf16 v[208:211], a[144:147], a[24:27], v[208:211]
    ds_read_b64_tr_b16 a[184:185], v43 offset:10240
    v_mfma_f32_16x16x32_bf16 v[212:215], a[144:147], a[28:31], v[212:215]
    ds_read_b64_tr_b16 a[186:187], v43 offset:15360
    v_mfma_f32_16x16x32_bf16 v[216:219], a[148:151], a[24:27], v[216:219]
    ds_read_b64_tr_b16 a[188:189], v43 offset:10272
    buffer_load_dwordx4 v18, s[20:23], s79 offen offset:3072 lds
    s_add_u32 m0, s38, 106496
    s_add_u32 s41, s82, 65536
    v_mfma_f32_16x16x32_bf16 v[220:223], a[148:151], a[28:31], v[220:223]
    ds_read_b64_tr_b16 a[190:191], v43 offset:15392
    v_mfma_f32_16x16x32_bf16 v[224:227], a[152:155], a[24:27], v[224:227]
    ds_read_b64_tr_b16 a[192:193], v43 offset:10304
    v_mfma_f32_16x16x32_bf16 v[228:231], a[152:155], a[28:31], v[228:231]
    ds_read_b64_tr_b16 a[194:195], v43 offset:15424
    buffer_load_dwordx4 a[0:3], v47, s[16:19], s41 offen offset:0 sc1
    v_mfma_f32_16x16x32_bf16 v[232:235], a[156:159], a[24:27], v[232:235]
    ds_read_b64_tr_b16 a[196:197], v43 offset:10336
    v_mfma_f32_16x16x32_bf16 v[236:239], a[156:159], a[28:31], v[236:239]
    ds_read_b64_tr_b16 a[198:199], v43 offset:15456
    v_mfma_f32_16x16x32_bf16 v[240:243], a[160:163], a[24:27], v[240:243]
    ds_read_b64_tr_b16 a[200:201], v43 offset:10368
    buffer_load_dwordx4 v19, s[20:23], s79 offen lds
    v_mfma_f32_16x16x32_bf16 v[244:247], a[160:163], a[28:31], v[244:247]
    ds_read_b64_tr_b16 a[202:203], v43 offset:15488
    s_waitcnt lgkmcnt(10)
    v_mfma_f32_16x16x32_bf16 v[72:75], a[164:167], a[24:27], v[72:75]
    ds_read_b64_tr_b16 a[204:205], v43 offset:10400
    v_mfma_f32_16x16x32_bf16 v[76:79], a[164:167], a[28:31], v[76:79]
    ds_read_b64_tr_b16 a[206:207], v43 offset:15520
    v_mfma_f32_16x16x32_bf16 v[88:91], a[168:171], a[24:27], v[88:91]
    ds_read_b64_tr_b16 a[208:209], v43 offset:10432
    buffer_load_dwordx4 a[4:7], v47, s[16:19], s41 offen offset:1024 sc1
    s_add_u32 s41, s83, 57344
    v_mfma_f32_16x16x32_bf16 v[92:95], a[168:171], a[28:31], v[92:95]
    ds_read_b64_tr_b16 a[210:211], v43 offset:15552
    v_mfma_f32_16x16x32_bf16 v[104:107], a[172:175], a[24:27], v[104:107]
    ds_read_b64_tr_b16 a[212:213], v43 offset:10464
    v_mfma_f32_16x16x32_bf16 v[108:111], a[172:175], a[28:31], v[108:111]
    ds_read_b64_tr_b16 a[214:215], v43 offset:15584
    buffer_load_dwordx4 a[8:11], v47, s[16:19], s41 offen offset:0 sc1
    v_mfma_f32_16x16x32_bf16 v[120:123], a[176:179], a[24:27], v[120:123]
    ds_read_b64_tr_b16 a[216:217], v43 offset:10496
    v_mfma_f32_16x16x32_bf16 v[124:127], a[176:179], a[28:31], v[124:127]
    ds_read_b64_tr_b16 a[218:219], v43 offset:15616
    s_waitcnt lgkmcnt(8)
    s_waitcnt vmcnt(15)
    v_mfma_f32_16x16x32_bf16 v[208:211], a[184:187], a[32:35], v[208:211]
    s_barrier
    ds_read_b64_tr_b16 a[144:145], v43 offset:20480
    buffer_load_dwordx4 a[12:15], v47, s[16:19], s41 offen offset:1024 sc1
    v_mfma_f32_16x16x32_bf16 v[212:215], a[184:187], a[36:39], v[212:215]
    ds_read_b64_tr_b16 a[146:147], v43 offset:25600
    v_mfma_f32_16x16x32_bf16 v[216:219], a[188:191], a[32:35], v[216:219]
    ds_read_b64_tr_b16 a[148:149], v43 offset:20512
    s_add_u32 s41, s83, 65536
    v_mfma_f32_16x16x32_bf16 v[220:223], a[188:191], a[36:39], v[220:223]
    ds_read_b64_tr_b16 a[150:151], v43 offset:25632
    v_mfma_f32_16x16x32_bf16 v[224:227], a[192:195], a[32:35], v[224:227]
    ds_read_b64_tr_b16 a[152:153], v43 offset:20544
    buffer_load_dwordx4 a[16:19], v47, s[16:19], s41 offen offset:0 sc1
    v_mfma_f32_16x16x32_bf16 v[228:231], a[192:195], a[36:39], v[228:231]
    ds_read_b64_tr_b16 a[154:155], v43 offset:25664
    v_mfma_f32_16x16x32_bf16 v[232:235], a[196:199], a[32:35], v[232:235]
    ds_read_b64_tr_b16 a[156:157], v43 offset:20576
    buffer_load_dwordx4 a[20:23], v47, s[16:19], s41 offen offset:1024 sc1
    v_mfma_f32_16x16x32_bf16 v[236:239], a[196:199], a[36:39], v[236:239]
    ds_read_b64_tr_b16 a[158:159], v43 offset:25696
    v_mfma_f32_16x16x32_bf16 v[240:243], a[200:203], a[32:35], v[240:243]
    ds_read_b64_tr_b16 a[160:161], v43 offset:20608
    v_mfma_f32_16x16x32_bf16 v[244:247], a[200:203], a[36:39], v[244:247]
    ds_read_b64_tr_b16 a[162:163], v43 offset:25728
    s_waitcnt lgkmcnt(10)
    v_mfma_f32_16x16x32_bf16 v[72:75], a[204:207], a[32:35], v[72:75]
    ds_read_b64_tr_b16 a[164:165], v43 offset:20640
    v_mfma_f32_16x16x32_bf16 v[76:79], a[204:207], a[36:39], v[76:79]
    ds_read_b64_tr_b16 a[166:167], v43 offset:25760
    v_mfma_f32_16x16x32_bf16 v[88:91], a[208:211], a[32:35], v[88:91]
    ds_read_b64_tr_b16 a[168:169], v43 offset:20672
    v_mfma_f32_16x16x32_bf16 v[92:95], a[208:211], a[36:39], v[92:95]
    ds_read_b64_tr_b16 a[170:171], v43 offset:25792
    v_mfma_f32_16x16x32_bf16 v[104:107], a[212:215], a[32:35], v[104:107]
    ds_read_b64_tr_b16 a[172:173], v43 offset:20704
    v_mfma_f32_16x16x32_bf16 v[108:111], a[212:215], a[36:39], v[108:111]
    ds_read_b64_tr_b16 a[174:175], v43 offset:25824
    v_mfma_f32_16x16x32_bf16 v[120:123], a[216:219], a[32:35], v[120:123]
    ds_read_b64_tr_b16 a[176:177], v43 offset:20736
    v_mfma_f32_16x16x32_bf16 v[124:127], a[216:219], a[36:39], v[124:127]
    ds_read_b64_tr_b16 a[178:179], v43 offset:25856
    s_waitcnt lgkmcnt(8)
    s_waitcnt vmcnt(16)
    v_mfma_f32_16x16x32_bf16 v[208:211], a[144:147], a[40:43], v[208:211]
    ds_read_b64_tr_b16 a[184:185], v43 offset:30720
    v_mfma_f32_16x16x32_bf16 v[212:215], a[144:147], a[44:47], v[212:215]
    ds_read_b64_tr_b16 a[186:187], v43 offset:35840
    s_lshl_b32 s84, s29, 2
    v_mfma_f32_16x16x32_bf16 v[216:219], a[148:151], a[40:43], v[216:219]
    ds_read_b64_tr_b16 a[188:189], v43 offset:30752
    s_add_u32 s84, s84, s33
    v_mfma_f32_16x16x32_bf16 v[220:223], a[148:151], a[44:47], v[220:223]
    ds_read_b64_tr_b16 a[190:191], v43 offset:35872
    s_lshl_b32 s84, s84, 2
    v_mfma_f32_16x16x32_bf16 v[224:227], a[152:155], a[40:43], v[224:227]
    ds_read_b64_tr_b16 a[192:193], v43 offset:30784
    v_lshlrev_b32 v53, 4, v1
    v_mfma_f32_16x16x32_bf16 v[228:231], a[152:155], a[44:47], v[228:231]
    ds_read_b64_tr_b16 a[194:195], v43 offset:35904
    s_add_u32 s85, s84, s28
    v_mfma_f32_16x16x32_bf16 v[232:235], a[156:159], a[40:43], v[232:235]
    ds_read_b64_tr_b16 a[196:197], v43 offset:30816
    s_lshl_b32 s85, s85, 2
    v_mfma_f32_16x16x32_bf16 v[236:239], a[156:159], a[44:47], v[236:239]
    ds_read_b64_tr_b16 a[198:199], v43 offset:35936
    s_add_u32 s85, s85, s32
    v_mfma_f32_16x16x32_bf16 v[240:243], a[160:163], a[40:43], v[240:243]
    ds_read_b64_tr_b16 a[200:201], v43 offset:30848
    s_mul_i32 s85, s85, 12288
    v_mfma_f32_16x16x32_bf16 v[244:247], a[160:163], a[44:47], v[244:247]
    ds_read_b64_tr_b16 a[202:203], v43 offset:35968
    s_waitcnt lgkmcnt(10)
    v_mfma_f32_16x16x32_bf16 v[72:75], a[164:167], a[40:43], v[72:75]
    ds_read_b64_tr_b16 a[204:205], v43 offset:30880
    s_add_u32 s85, s85, 20971520
    v_mfma_f32_16x16x32_bf16 v[76:79], a[164:167], a[44:47], v[76:79]
    ds_read_b64_tr_b16 a[206:207], v43 offset:36000
    s_add_u32 s86, s85, 4096
    v_mfma_f32_16x16x32_bf16 v[88:91], a[168:171], a[40:43], v[88:91]
    ds_read_b64_tr_b16 a[208:209], v43 offset:30912
    s_add_u32 s87, s85, 8192
    v_mfma_f32_16x16x32_bf16 v[92:95], a[168:171], a[44:47], v[92:95]
    ds_read_b64_tr_b16 a[210:211], v43 offset:36032
    v_mov_b32 v23, s43
    v_mfma_f32_16x16x32_bf16 v[104:107], a[172:175], a[40:43], v[104:107]
    ds_read_b64_tr_b16 a[212:213], v43 offset:30944
    v_mov_b32 v27, s43
    v_mfma_f32_16x16x32_bf16 v[108:111], a[172:175], a[44:47], v[108:111]
    ds_read_b64_tr_b16 a[214:215], v43 offset:36064
    v_mov_b32 v31, s43
    v_mfma_f32_16x16x32_bf16 v[120:123], a[176:179], a[40:43], v[120:123]
    ds_read_b64_tr_b16 a[216:217], v43 offset:30976
    v_mov_b32 v35, s43
    v_mfma_f32_16x16x32_bf16 v[124:127], a[176:179], a[44:47], v[124:127]
    ds_read_b64_tr_b16 a[218:219], v43 offset:36096
    s_waitcnt lgkmcnt(8)
    s_waitcnt vmcnt(13)
    s_waitcnt vmcnt(5)
    v_mfma_f32_16x16x32_bf16 v[208:211], a[184:187], a[48:51], v[208:211]
    s_barrier
    ds_read_b64_tr_b16 a[144:145], v42 offset:0
    v_mfma_f32_16x16x32_bf16 v[212:215], a[184:187], a[52:55], v[212:215]
    ds_read_b64_tr_b16 a[146:147], v42 offset:5120
    v_mfma_f32_16x16x32_bf16 v[216:219], a[188:191], a[48:51], v[216:219]
    ds_read_b64_tr_b16 a[148:149], v42 offset:10240
    v_mfma_f32_16x16x32_bf16 v[220:223], a[188:191], a[52:55], v[220:223]
    ds_read_b64_tr_b16 a[150:151], v42 offset:15360
    v_mfma_f32_16x16x32_bf16 v[224:227], a[192:195], a[48:51], v[224:227]
    ds_read_b64_tr_b16 a[152:153], v43 offset:40960
    v_mfma_f32_16x16x32_bf16 v[228:231], a[192:195], a[52:55], v[228:231]
    ds_read_b64_tr_b16 a[154:155], v43 offset:46080
    v_mfma_f32_16x16x32_bf16 v[232:235], a[196:199], a[48:51], v[232:235]
    ds_read_b64_tr_b16 a[156:157], v43 offset:51200
    v_mfma_f32_16x16x32_bf16 v[236:239], a[196:199], a[52:55], v[236:239]
    ds_read_b64_tr_b16 a[158:159], v43 offset:56320
    v_mfma_f32_16x16x32_bf16 v[240:243], a[200:203], a[48:51], v[240:243]
    ds_read_b64_tr_b16 a[160:161], v42 offset:32
    v_mfma_f32_16x16x32_bf16 v[244:247], a[200:203], a[52:55], v[244:247]
    ds_read_b64_tr_b16 a[162:163], v42 offset:5152
    s_waitcnt lgkmcnt(10)
    v_mfma_f32_16x16x32_bf16 v[72:75], a[204:207], a[48:51], v[72:75]
    ds_read_b64_tr_b16 a[164:165], v42 offset:10272
    v_mfma_f32_16x16x32_bf16 v[76:79], a[204:207], a[52:55], v[76:79]
    ds_read_b64_tr_b16 a[166:167], v42 offset:15392
    v_mfma_f32_16x16x32_bf16 v[88:91], a[208:211], a[48:51], v[88:91]
    ds_read_b64_tr_b16 a[168:169], v43 offset:40992
    v_mfma_f32_16x16x32_bf16 v[92:95], a[208:211], a[52:55], v[92:95]
    ds_read_b64_tr_b16 a[170:171], v43 offset:46112
    v_mfma_f32_16x16x32_bf16 v[104:107], a[212:215], a[48:51], v[104:107]
    ds_read_b64_tr_b16 a[172:173], v43 offset:51232
    v_mfma_f32_16x16x32_bf16 v[108:111], a[212:215], a[52:55], v[108:111]
    ds_read_b64_tr_b16 a[174:175], v43 offset:56352
    v_mfma_f32_16x16x32_bf16 v[120:123], a[216:219], a[48:51], v[120:123]
    v_mfma_f32_16x16x32_bf16 v[124:127], a[216:219], a[52:55], v[124:127]
    s_waitcnt lgkmcnt(8)
    s_waitcnt vmcnt(0)
    s_cmp_eq_u32 s28, s32
    s_cbranch_scc1 L_owner
    v_mfma_f32_16x16x32_bf16 v[208:211], a[144:147], a[56:59], v[208:211]
    ds_read_b64_tr_b16 a[184:185], v42 offset:64
    v_mfma_f32_16x16x32_bf16 v[212:215], a[144:147], a[60:63], v[212:215]
    ds_read_b64_tr_b16 a[186:187], v42 offset:5184
    v_mfma_f32_16x16x32_bf16 v[208:211], a[148:151], a[0:3], v[208:211]
    ds_read_b64_tr_b16 a[188:189], v42 offset:10304
    v_mfma_f32_16x16x32_bf16 v[212:215], a[148:151], a[4:7], v[212:215]
    ds_read_b64_tr_b16 a[190:191], v42 offset:15424
    v_mfma_f32_16x16x32_bf16 v[208:211], a[152:155], a[8:11], v[208:211]
    ds_read_b64_tr_b16 a[192:193], v43 offset:41024
    v_mfma_f32_16x16x32_bf16 v[212:215], a[152:155], a[12:15], v[212:215]
    ds_read_b64_tr_b16 a[194:195], v43 offset:46144
    v_mfma_f32_16x16x32_bf16 v[208:211], a[156:159], a[16:19], v[208:211]
    ds_read_b64_tr_b16 a[196:197], v43 offset:51264
    v_mfma_f32_16x16x32_bf16 v[212:215], a[156:159], a[20:23], v[212:215]
    ds_read_b64_tr_b16 a[198:199], v43 offset:56384
    s_waitcnt lgkmcnt(8)
    v_mfma_f32_16x16x32_bf16 v[216:219], a[160:163], a[56:59], v[216:219]
    ds_read_b64_tr_b16 a[200:201], v42 offset:96
    v_mfma_f32_16x16x32_bf16 v[220:223], a[160:163], a[60:63], v[220:223]
    ds_read_b64_tr_b16 a[202:203], v42 offset:5216
    v_mfma_f32_16x16x32_bf16 v[216:219], a[164:167], a[0:3], v[216:219]
    ds_read_b64_tr_b16 a[204:205], v42 offset:10336
    v_mfma_f32_16x16x32_bf16 v[220:223], a[164:167], a[4:7], v[220:223]
    ds_read_b64_tr_b16 a[206:207], v42 offset:15456
    v_mfma_f32_16x16x32_bf16 v[216:219], a[168:171], a[8:11], v[216:219]
    ds_read_b64_tr_b16 a[208:209], v43 offset:41056
    v_cvt_pk_bf16_f32 v20, v208, v209
    v_mfma_f32_16x16x32_bf16 v[220:223], a[168:171], a[12:15], v[220:223]
    ds_read_b64_tr_b16 a[210:211], v43 offset:46176
    v_cvt_pk_bf16_f32 v21, v210, v211
    v_mfma_f32_16x16x32_bf16 v[216:219], a[172:175], a[16:19], v[216:219]
    ds_read_b64_tr_b16 a[212:213], v43 offset:51296
    v_cvt_pk_bf16_f32 v22, v212, v213
    v_mfma_f32_16x16x32_bf16 v[220:223], a[172:175], a[20:23], v[220:223]
    ds_read_b64_tr_b16 a[214:215], v43 offset:56416
    s_waitcnt lgkmcnt(8)
    v_mfma_f32_16x16x32_bf16 v[224:227], a[184:187], a[56:59], v[224:227]
    ds_read_b64_tr_b16 a[144:145], v42 offset:128
    buffer_store_dwordx4 v[20:23], v53, s[16:19], s85 offen offset:0 sc1
    v_mfma_f32_16x16x32_bf16 v[228:231], a[184:187], a[60:63], v[228:231]
    ds_read_b64_tr_b16 a[146:147], v42 offset:5248
    v_mfma_f32_16x16x32_bf16 v[224:227], a[188:191], a[0:3], v[224:227]
    ds_read_b64_tr_b16 a[148:149], v42 offset:10368
    v_mfma_f32_16x16x32_bf16 v[228:231], a[188:191], a[4:7], v[228:231]
    ds_read_b64_tr_b16 a[150:151], v42 offset:15488
    v_cvt_pk_bf16_f32 v24, v214, v215
    v_mfma_f32_16x16x32_bf16 v[224:227], a[192:195], a[8:11], v[224:227]
    ds_read_b64_tr_b16 a[152:153], v43 offset:41088
    v_cvt_pk_bf16_f32 v25, v216, v217
    v_mfma_f32_16x16x32_bf16 v[228:231], a[192:195], a[12:15], v[228:231]
    ds_read_b64_tr_b16 a[154:155], v43 offset:46208
    v_cvt_pk_bf16_f32 v26, v218, v219
    v_mfma_f32_16x16x32_bf16 v[224:227], a[196:199], a[16:19], v[224:227]
    ds_read_b64_tr_b16 a[156:157], v43 offset:51328
    buffer_store_dwordx4 v[24:27], v53, s[16:19], s85 offen offset:1024 sc1
    v_mfma_f32_16x16x32_bf16 v[228:231], a[196:199], a[20:23], v[228:231]
    ds_read_b64_tr_b16 a[158:159], v43 offset:56448
    s_waitcnt lgkmcnt(8)
    v_mfma_f32_16x16x32_bf16 v[232:235], a[200:203], a[56:59], v[232:235]
    ds_read_b64_tr_b16 a[160:161], v42 offset:160
    v_mfma_f32_16x16x32_bf16 v[236:239], a[200:203], a[60:63], v[236:239]
    ds_read_b64_tr_b16 a[162:163], v42 offset:5280
    v_mfma_f32_16x16x32_bf16 v[232:235], a[204:207], a[0:3], v[232:235]
    ds_read_b64_tr_b16 a[164:165], v42 offset:10400
    v_mfma_f32_16x16x32_bf16 v[236:239], a[204:207], a[4:7], v[236:239]
    ds_read_b64_tr_b16 a[166:167], v42 offset:15520
    v_cvt_pk_bf16_f32 v28, v220, v221
    v_mfma_f32_16x16x32_bf16 v[232:235], a[208:211], a[8:11], v[232:235]
    ds_read_b64_tr_b16 a[168:169], v43 offset:41120
    v_cvt_pk_bf16_f32 v29, v222, v223
    v_mfma_f32_16x16x32_bf16 v[236:239], a[208:211], a[12:15], v[236:239]
    ds_read_b64_tr_b16 a[170:171], v43 offset:46240
    v_cvt_pk_bf16_f32 v30, v224, v225
    v_mfma_f32_16x16x32_bf16 v[232:235], a[212:215], a[16:19], v[232:235]
    ds_read_b64_tr_b16 a[172:173], v43 offset:51360
    buffer_store_dwordx4 v[28:31], v53, s[16:19], s85 offen offset:2048 sc1
    v_cvt_pk_bf16_f32 v32, v226, v227
    v_mfma_f32_16x16x32_bf16 v[236:239], a[212:215], a[20:23], v[236:239]
    ds_read_b64_tr_b16 a[174:175], v43 offset:56480
    v_cvt_pk_bf16_f32 v33, v228, v229
    s_waitcnt lgkmcnt(8)
    v_mfma_f32_16x16x32_bf16 v[240:243], a[144:147], a[56:59], v[240:243]
    ds_read_b64_tr_b16 a[184:185], v42 offset:192
    v_cvt_pk_bf16_f32 v34, v230, v231
    v_mfma_f32_16x16x32_bf16 v[244:247], a[144:147], a[60:63], v[244:247]
    ds_read_b64_tr_b16 a[186:187], v42 offset:5312
    buffer_store_dwordx4 v[32:35], v53, s[16:19], s85 offen offset:3072 sc1
    v_mfma_f32_16x16x32_bf16 v[240:243], a[148:151], a[0:3], v[240:243]
    ds_read_b64_tr_b16 a[188:189], v42 offset:10432
    v_mfma_f32_16x16x32_bf16 v[244:247], a[148:151], a[4:7], v[244:247]
    ds_read_b64_tr_b16 a[190:191], v42 offset:15552
    v_mfma_f32_16x16x32_bf16 v[240:243], a[152:155], a[8:11], v[240:243]
    ds_read_b64_tr_b16 a[192:193], v43 offset:41152
    v_cvt_pk_bf16_f32 v20, v232, v233
    v_mfma_f32_16x16x32_bf16 v[244:247], a[152:155], a[12:15], v[244:247]
    ds_read_b64_tr_b16 a[194:195], v43 offset:46272
    v_cvt_pk_bf16_f32 v21, v234, v235
    v_mfma_f32_16x16x32_bf16 v[240:243], a[156:159], a[16:19], v[240:243]
    ds_read_b64_tr_b16 a[196:197], v43 offset:51392
    v_cvt_pk_bf16_f32 v22, v236, v237
    v_mfma_f32_16x16x32_bf16 v[244:247], a[156:159], a[20:23], v[244:247]
    ds_read_b64_tr_b16 a[198:199], v43 offset:56512
    s_waitcnt lgkmcnt(8)
    v_mfma_f32_16x16x32_bf16 v[72:75], a[160:163], a[56:59], v[72:75]
    ds_read_b64_tr_b16 a[200:201], v42 offset:224
    buffer_store_dwordx4 v[20:23], v53, s[16:19], s86 offen offset:0 sc1
    v_mfma_f32_16x16x32_bf16 v[76:79], a[160:163], a[60:63], v[76:79]
    ds_read_b64_tr_b16 a[202:203], v42 offset:5344
    v_mfma_f32_16x16x32_bf16 v[72:75], a[164:167], a[0:3], v[72:75]
    ds_read_b64_tr_b16 a[204:205], v42 offset:10464
    v_mfma_f32_16x16x32_bf16 v[76:79], a[164:167], a[4:7], v[76:79]
    ds_read_b64_tr_b16 a[206:207], v42 offset:15584
    v_cvt_pk_bf16_f32 v24, v238, v239
    v_mfma_f32_16x16x32_bf16 v[72:75], a[168:171], a[8:11], v[72:75]
    ds_read_b64_tr_b16 a[208:209], v43 offset:41184
    v_cvt_pk_bf16_f32 v25, v240, v241
    v_mfma_f32_16x16x32_bf16 v[76:79], a[168:171], a[12:15], v[76:79]
    ds_read_b64_tr_b16 a[210:211], v43 offset:46304
    v_cvt_pk_bf16_f32 v26, v242, v243
    v_mfma_f32_16x16x32_bf16 v[72:75], a[172:175], a[16:19], v[72:75]
    ds_read_b64_tr_b16 a[212:213], v43 offset:51424
    buffer_store_dwordx4 v[24:27], v53, s[16:19], s86 offen offset:1024 sc1
    v_mfma_f32_16x16x32_bf16 v[76:79], a[172:175], a[20:23], v[76:79]
    ds_read_b64_tr_b16 a[214:215], v43 offset:56544
    s_waitcnt lgkmcnt(8)
    v_mfma_f32_16x16x32_bf16 v[88:91], a[184:187], a[56:59], v[88:91]
    ds_read_b64_tr_b16 a[144:145], v42 offset:256
    v_mfma_f32_16x16x32_bf16 v[92:95], a[184:187], a[60:63], v[92:95]
    ds_read_b64_tr_b16 a[146:147], v42 offset:5376
    v_mfma_f32_16x16x32_bf16 v[88:91], a[188:191], a[0:3], v[88:91]
    ds_read_b64_tr_b16 a[148:149], v42 offset:10496
    v_mfma_f32_16x16x32_bf16 v[92:95], a[188:191], a[4:7], v[92:95]
    ds_read_b64_tr_b16 a[150:151], v42 offset:15616
    v_cvt_pk_bf16_f32 v28, v244, v245
    v_mfma_f32_16x16x32_bf16 v[88:91], a[192:195], a[8:11], v[88:91]
    ds_read_b64_tr_b16 a[152:153], v43 offset:41216
    v_cvt_pk_bf16_f32 v29, v246, v247
    v_mfma_f32_16x16x32_bf16 v[92:95], a[192:195], a[12:15], v[92:95]
    ds_read_b64_tr_b16 a[154:155], v43 offset:46336
    v_cvt_pk_bf16_f32 v30, v72, v73
    v_mfma_f32_16x16x32_bf16 v[88:91], a[196:199], a[16:19], v[88:91]
    ds_read_b64_tr_b16 a[156:157], v43 offset:51456
    buffer_store_dwordx4 v[28:31], v53, s[16:19], s86 offen offset:2048 sc1
    v_cvt_pk_bf16_f32 v32, v74, v75
    v_mfma_f32_16x16x32_bf16 v[92:95], a[196:199], a[20:23], v[92:95]
    ds_read_b64_tr_b16 a[158:159], v43 offset:56576
    v_cvt_pk_bf16_f32 v33, v76, v77
    s_waitcnt lgkmcnt(8)
    v_mfma_f32_16x16x32_bf16 v[104:107], a[200:203], a[56:59], v[104:107]
    v_cvt_pk_bf16_f32 v34, v78, v79
    buffer_store_dwordx4 v[32:35], v53, s[16:19], s86 offen offset:3072 sc1
    v_mfma_f32_16x16x32_bf16 v[108:111], a[200:203], a[60:63], v[108:111]
    v_mfma_f32_16x16x32_bf16 v[104:107], a[204:207], a[0:3], v[104:107]
    v_mfma_f32_16x16x32_bf16 v[108:111], a[204:207], a[4:7], v[108:111]
    v_mfma_f32_16x16x32_bf16 v[104:107], a[208:211], a[8:11], v[104:107]
    v_mfma_f32_16x16x32_bf16 v[108:111], a[208:211], a[12:15], v[108:111]
    v_mfma_f32_16x16x32_bf16 v[104:107], a[212:215], a[16:19], v[104:107]
    v_mfma_f32_16x16x32_bf16 v[108:111], a[212:215], a[20:23], v[108:111]
    v_cvt_pk_bf16_f32 v20, v88, v89
    s_waitcnt lgkmcnt(0)
    v_mfma_f32_16x16x32_bf16 v[120:123], a[144:147], a[56:59], v[120:123]
    v_cvt_pk_bf16_f32 v21, v90, v91
    v_cvt_pk_bf16_f32 v22, v92, v93
    v_mfma_f32_16x16x32_bf16 v[124:127], a[144:147], a[60:63], v[124:127]
    buffer_store_dwordx4 v[20:23], v53, s[16:19], s87 offen offset:0 sc1
    v_mfma_f32_16x16x32_bf16 v[120:123], a[148:151], a[0:3], v[120:123]
    v_mfma_f32_16x16x32_bf16 v[124:127], a[148:151], a[4:7], v[124:127]
    v_mfma_f32_16x16x32_bf16 v[120:123], a[152:155], a[8:11], v[120:123]
    v_mfma_f32_16x16x32_bf16 v[124:127], a[152:155], a[12:15], v[124:127]
    v_mfma_f32_16x16x32_bf16 v[120:123], a[156:159], a[16:19], v[120:123]
    v_cvt_pk_bf16_f32 v24, v94, v95
    v_cvt_pk_bf16_f32 v25, v104, v105
    v_mfma_f32_16x16x32_bf16 v[124:127], a[156:159], a[20:23], v[124:127]
    v_cvt_pk_bf16_f32 v26, v106, v107
    buffer_store_dwordx4 v[24:27], v53, s[16:19], s87 offen offset:1024 sc1
    s_nop 7
    v_cvt_pk_bf16_f32 v28, v108, v109
    v_cvt_pk_bf16_f32 v29, v110, v111
    v_cvt_pk_bf16_f32 v30, v120, v121
    buffer_store_dwordx4 v[28:31], v53, s[16:19], s87 offen offset:2048 sc1
    v_cvt_pk_bf16_f32 v32, v122, v123
    v_cvt_pk_bf16_f32 v33, v124, v125
    v_cvt_pk_bf16_f32 v34, v126, v127
    buffer_store_dwordx4 v[32:35], v53, s[16:19], s87 offen offset:3072 sc1
    s_sub_u32 s88, s28, s32
    s_sub_u32 s88, s88, 1
    s_and_b32 s88, s88, 3
    s_add_u32 s85, s84, s32
    s_lshl_b32 s85, s85, 2
    s_lshl_b32 s87, s88, 12
    s_add_u32 s87, s87, 20971520
    s_add_u32 s86, s32, 1
    s_and_b32 s86, s86, 3
    s_add_u32 s86, s86, s85
    s_mul_i32 s86, s86, 12288
    s_add_u32 s45, s86, s87
    s_add_u32 s86, s32, 2
    s_and_b32 s86, s86, 3
    s_add_u32 s86, s86, s85
    s_mul_i32 s86, s86, 12288
    s_add_u32 s46, s86, s87
    s_add_u32 s86, s32, 3
    s_and_b32 s86, s86, 3
    s_add_u32 s86, s86, s85
    s_mul_i32 s86, s86, 12288
    s_add_u32 s47, s86, s87
    v_min_u32 v60, 2, v1
    v_mov_b32 v61, s45
    v_mov_b32 v58, s46
    v_cmp_eq_u32 vcc, 1, v60
    s_mul_i32 s87, s88, 6144
    s_add_u32 s87, s87, 61440
    v_cndmask_b32 v61, v61, v58, vcc
    v_mov_b32 v58, s47
    v_cmp_eq_u32 vcc, 2, v60
    s_lshl_b32 s86, s29, 7
    s_lshl_b32 s85, s32, 5
    v_cndmask_b32 v61, v61, v58, vcc
    v_add_u32 v59, 4092, v61
    s_add_u32 s86, s86, s85
    s_mul_i32 s86, s86, 1152
    s_mul_i32 s85, s33, 288
    s_add_u32 s86, s86, s85
    s_mul_i32 s85, s88, 96
    s_add_u32 s86, s86, s85
    v_and_b32 v54, 15, v1
    v_mul_u32_u24 v54, 1152, v54
    v_add_u32 v54, v54, v48
    v_add_u32 v55, 18432, v54
    v_add_u32 v49, s87, v53
    s_mov_b32 s89, 0xffff0000
    buffer_load_dword v51, v59, s[16:19], 0 offen sc1
    s_barrier
    ds_read_b128 v[128:131], v49 offset:0
    ds_read_b128 v[132:135], v49 offset:1024
    ds_read_b128 v[136:139], v49 offset:2048
    ds_read_b128 v[140:143], v49 offset:3072
    ds_read_b128 v[144:147], v49 offset:4096
    ds_read_b128 v[148:151], v49 offset:5120
    s_mov_b32 s91, 65536
    s_mov_b32 s3, 64
L_redo:
    s_mov_b32 s91, 65536
L_tw_chk:
    s_waitcnt vmcnt(0)
    v_cmp_ne_u32 vcc, s43, v51
    s_nop 3
    s_cmp_eq_u64 vcc, 0
    s_cbranch_scc1 L_tw_go
    s_sub_u32 s91, s91, 1
    s_cmp_le_i32 s91, 0
    s_cbranch_scc1 L_tw_go
    buffer_load_dword v51, v59, s[16:19], 0 offen sc1
    s_branch L_tw_chk
L_tw_go:
    v_mov_b32 v58, 0
    buffer_load_dwordx4 v[152:155], v53, s[16:19], s45 offen offset:0 sc1
    buffer_load_dwordx4 v[156:159], v53, s[16:19], s46 offen offset:0 sc1
    buffer_load_dwordx4 v[160:163], v53, s[16:19], s47 offen offset:0 sc1
    buffer_load_dwordx4 v[164:167], v53, s[16:19], s45 offen offset:1024 sc1
    buffer_load_dwordx4 v[168:171], v53, s[16:19], s46 offen offset:1024 sc1
    buffer_load_dwordx4 v[172:175], v53, s[16:19], s47 offen offset:1024 sc1
    buffer_load_dwordx4 v[176:179], v53, s[16:19], s45 offen offset:2048 sc1
    buffer_load_dwordx4 v[180:183], v53, s[16:19], s46 offen offset:2048 sc1
    buffer_load_dwordx4 v[184:187], v53, s[16:19], s47 offen offset:2048 sc1
    buffer_load_dwordx4 v[188:191], v53, s[16:19], s45 offen offset:3072 sc1
    buffer_load_dwordx4 v[192:195], v53, s[16:19], s46 offen offset:3072 sc1
    buffer_load_dwordx4 v[196:199], v53, s[16:19], s47 offen offset:3072 sc1
    s_waitcnt lgkmcnt(0)
    s_waitcnt vmcnt(9)
    v_xor_b32 v43, s43, v155
    v_xor_b32 v44, s43, v159
    v_or3_b32 v58, v43, v44, v58
    v_xor_b32 v43, s43, v163
    v_or_b32 v58, v43, v58
    v_lshlrev_b32 v40, 16, v152
    v_lshlrev_b32 v41, 16, v156
    v_lshlrev_b32 v42, 16, v160
    v_add_f32 v36, v128, v40
    v_add_f32 v41, v41, v42
    v_add_f32 v36, v36, v41
    v_and_b32 v40, s89, v152
    v_and_b32 v41, s89, v156
    v_and_b32 v42, s89, v160
    v_add_f32 v37, v129, v40
    v_add_f32 v41, v41, v42
    v_add_f32 v37, v37, v41
    v_lshlrev_b32 v40, 16, v153
    v_lshlrev_b32 v41, 16, v157
    v_lshlrev_b32 v42, 16, v161
    v_add_f32 v38, v130, v40
    v_add_f32 v41, v41, v42
    v_add_f32 v38, v38, v41
    v_and_b32 v40, s89, v153
    v_and_b32 v41, s89, v157
    v_and_b32 v42, s89, v161
    v_add_f32 v39, v131, v40
    v_add_f32 v41, v41, v42
    v_add_f32 v39, v39, v41
    v_cvt_pk_bf16_f32 v46, v36, v37
    v_cvt_pk_bf16_f32 v47, v38, v39
    buffer_store_dwordx2 v[46:47], v54, s[24:27], s86 offen offset:0
    s_waitcnt vmcnt(7)
    v_xor_b32 v43, s43, v167
    v_xor_b32 v44, s43, v171
    v_or3_b32 v58, v43, v44, v58
    v_xor_b32 v43, s43, v175
    v_or_b32 v58, v43, v58
    v_lshlrev_b32 v40, 16, v154
    v_lshlrev_b32 v41, 16, v158
    v_lshlrev_b32 v42, 16, v162
    v_add_f32 v36, v132, v40
    v_add_f32 v41, v41, v42
    v_add_f32 v36, v36, v41
    v_and_b32 v40, s89, v154
    v_and_b32 v41, s89, v158
    v_and_b32 v42, s89, v162
    v_add_f32 v37, v133, v40
    v_add_f32 v41, v41, v42
    v_add_f32 v37, v37, v41
    v_lshlrev_b32 v40, 16, v164
    v_lshlrev_b32 v41, 16, v168
    v_lshlrev_b32 v42, 16, v172
    v_add_f32 v38, v134, v40
    v_add_f32 v41, v41, v42
    v_add_f32 v38, v38, v41
    v_and_b32 v40, s89, v164
    v_and_b32 v41, s89, v168
    v_and_b32 v42, s89, v172
    v_add_f32 v39, v135, v40
    v_add_f32 v41, v41, v42
    v_add_f32 v39, v39, v41
    v_cvt_pk_bf16_f32 v2, v36, v37
    v_cvt_pk_bf16_f32 v3, v38, v39
    buffer_store_dwordx2 v[2:3], v55, s[24:27], s86 offen offset:0
    v_lshlrev_b32 v40, 16, v165
    v_lshlrev_b32 v41, 16, v169
    v_lshlrev_b32 v42, 16, v173
    v_add_f32 v36, v136, v40
    v_add_f32 v41, v41, v42
    v_add_f32 v36, v36, v41
    v_and_b32 v40, s89, v165
    v_and_b32 v41, s89, v169
    v_and_b32 v42, s89, v173
    v_add_f32 v37, v137, v40
    v_add_f32 v41, v41, v42
    v_add_f32 v37, v37, v41
    v_lshlrev_b32 v40, 16, v166
    v_lshlrev_b32 v41, 16, v170
    v_lshlrev_b32 v42, 16, v174
    v_add_f32 v38, v138, v40
    v_add_f32 v41, v41, v42
    v_add_f32 v38, v38, v41
    v_and_b32 v40, s89, v166
    v_and_b32 v41, s89, v170
    v_and_b32 v42, s89, v174
    v_add_f32 v39, v139, v40
    v_add_f32 v41, v41, v42
    v_add_f32 v39, v39, v41
    v_cvt_pk_bf16_f32 v46, v36, v37
    v_cvt_pk_bf16_f32 v47, v38, v39
    buffer_store_dwordx2 v[46:47], v54, s[24:27], s86 offen offset:32
    s_waitcnt vmcnt(6)
    v_xor_b32 v43, s43, v179
    v_xor_b32 v44, s43, v183
    v_or3_b32 v58, v43, v44, v58
    v_xor_b32 v43, s43, v187
    v_or_b32 v58, v43, v58
    v_lshlrev_b32 v40, 16, v176
    v_lshlrev_b32 v41, 16, v180
    v_lshlrev_b32 v42, 16, v184
    v_add_f32 v36, v140, v40
    v_add_f32 v41, v41, v42
    v_add_f32 v36, v36, v41
    v_and_b32 v40, s89, v176
    v_and_b32 v41, s89, v180
    v_and_b32 v42, s89, v184
    v_add_f32 v37, v141, v40
    v_add_f32 v41, v41, v42
    v_add_f32 v37, v37, v41
    v_lshlrev_b32 v40, 16, v177
    v_lshlrev_b32 v41, 16, v181
    v_lshlrev_b32 v42, 16, v185
    v_add_f32 v38, v142, v40
    v_add_f32 v41, v41, v42
    v_add_f32 v38, v38, v41
    v_and_b32 v40, s89, v177
    v_and_b32 v41, s89, v181
    v_and_b32 v42, s89, v185
    v_add_f32 v39, v143, v40
    v_add_f32 v41, v41, v42
    v_add_f32 v39, v39, v41
    v_cvt_pk_bf16_f32 v2, v36, v37
    v_cvt_pk_bf16_f32 v3, v38, v39
    buffer_store_dwordx2 v[2:3], v55, s[24:27], s86 offen offset:32
    s_waitcnt vmcnt(4)
    v_xor_b32 v43, s43, v191
    v_xor_b32 v44, s43, v195
    v_or3_b32 v58, v43, v44, v58
    v_xor_b32 v43, s43, v199
    v_or_b32 v58, v43, v58
    v_lshlrev_b32 v40, 16, v178
    v_lshlrev_b32 v41, 16, v182
    v_lshlrev_b32 v42, 16, v186
    v_add_f32 v36, v144, v40
    v_add_f32 v41, v41, v42
    v_add_f32 v36, v36, v41
    v_and_b32 v40, s89, v178
    v_and_b32 v41, s89, v182
    v_and_b32 v42, s89, v186
    v_add_f32 v37, v145, v40
    v_add_f32 v41, v41, v42
    v_add_f32 v37, v37, v41
    v_lshlrev_b32 v40, 16, v188
    v_lshlrev_b32 v41, 16, v192
    v_lshlrev_b32 v42, 16, v196
    v_add_f32 v38, v146, v40
    v_add_f32 v41, v41, v42
    v_add_f32 v38, v38, v41
    v_and_b32 v40, s89, v188
    v_and_b32 v41, s89, v192
    v_and_b32 v42, s89, v196
    v_add_f32 v39, v147, v40
    v_add_f32 v41, v41, v42
    v_add_f32 v39, v39, v41
    v_cvt_pk_bf16_f32 v46, v36, v37
    v_cvt_pk_bf16_f32 v47, v38, v39
    buffer_store_dwordx2 v[46:47], v54, s[24:27], s86 offen offset:64
    v_lshlrev_b32 v40, 16, v189
    v_lshlrev_b32 v41, 16, v193
    v_lshlrev_b32 v42, 16, v197
    v_add_f32 v36, v148, v40
    v_add_f32 v41, v41, v42
    v_add_f32 v36, v36, v41
    v_and_b32 v40, s89, v189
    v_and_b32 v41, s89, v193
    v_and_b32 v42, s89, v197
    v_add_f32 v37, v149, v40
    v_add_f32 v41, v41, v42
    v_add_f32 v37, v37, v41
    v_lshlrev_b32 v40, 16, v190
    v_lshlrev_b32 v41, 16, v194
    v_lshlrev_b32 v42, 16, v198
    v_add_f32 v38, v150, v40
    v_add_f32 v41, v41, v42
    v_add_f32 v38, v38, v41
    v_and_b32 v40, s89, v190
    v_and_b32 v41, s89, v194
    v_and_b32 v42, s89, v198
    v_add_f32 v39, v151, v40
    v_add_f32 v41, v41, v42
    v_add_f32 v39, v39, v41
    v_cvt_pk_bf16_f32 v2, v36, v37
    v_cvt_pk_bf16_f32 v3, v38, v39
    buffer_store_dwordx2 v[2:3], v55, s[24:27], s86 offen offset:64
    v_cmp_ne_u32 vcc, 0, v58
    s_nop 3
    s_cmp_eq_u64 vcc, 0
    s_cbranch_scc1 L_tdone
    s_sub_u32 s3, s3, 1
    s_cmp_eq_u32 s3, 0
    s_cbranch_scc1 L_tdone
    s_waitcnt vmcnt(0)
    buffer_load_dword v51, v59, s[16:19], 0 offen sc1
    s_branch L_redo
L_tdone:
L_end:
    s_endpgm
L_nonce_1_slow:
    s_mov_b32 s91, 65536
L_nonce_1_spin:
    buffer_load_dword v51, v52, s[92:95], 0 offen sc1
    s_waitcnt vmcnt(0)
    v_cmp_eq_u32 vcc, 0, v51
    s_nop 1
    s_cbranch_vccz L_nonce_1_back
    s_sub_u32 s91, s91, 1
    s_cmp_lg_u32 s91, 0
    s_cbranch_scc1 L_nonce_1_spin
    s_branch L_nonce_1_back
L_flag0_2_slow:
    s_mov_b32 s91, 65536
L_flag0_2_spin:
    buffer_load_dword v51, v49, s[16:19], 0 offen offset:0 sc1
    s_waitcnt vmcnt(0)
    v_cmp_ne_u32 vcc, s43, v51
    s_nop 1
    s_cbranch_vccz L_flag0_2_back
    s_sub_u32 s91, s91, 1
    s_cmp_lg_u32 s91, 0
    s_cbranch_scc1 L_flag0_2_spin
    s_branch L_flag0_2_back
L_flag1_3_slow:
    s_mov_b32 s91, 65536
L_flag1_3_spin:
    buffer_load_dword v51, v49, s[16:19], 0 offen offset:4 sc1
    s_waitcnt vmcnt(0)
    v_cmp_ne_u32 vcc, s43, v51
    s_nop 1
    s_cbranch_vccz L_flag1_3_back
    s_sub_u32 s91, s91, 1
    s_cmp_lg_u32 s91, 0
    s_cbranch_scc1 L_flag1_3_spin
    s_branch L_flag1_3_back
L_flag2_4_slow:
    s_mov_b32 s91, 65536
L_flag2_4_spin:
    buffer_load_dword v51, v49, s[16:19], 0 offen offset:8 sc1
    s_waitcnt vmcnt(0)
    v_cmp_ne_u32 vcc, s43, v51
    s_nop 1
    s_cbranch_vccz L_flag2_4_back
    s_sub_u32 s91, s91, 1
    s_cmp_lg_u32 s91, 0
    s_cbranch_scc1 L_flag2_4_spin
    s_branch L_flag2_4_back
L_owner:
    v_mfma_f32_16x16x32_bf16 v[208:211], a[144:147], a[56:59], v[208:211]
    ds_read_b64_tr_b16 a[184:185], v42 offset:64
    v_mfma_f32_16x16x32_bf16 v[212:215], a[144:147], a[60:63], v[212:215]
    ds_read_b64_tr_b16 a[186:187], v42 offset:5184
    v_mfma_f32_16x16x32_bf16 v[208:211], a[148:151], a[0:3], v[208:211]
    ds_read_b64_tr_b16 a[188:189], v42 offset:10304
    v_mfma_f32_16x16x32_bf16 v[212:215], a[148:151], a[4:7], v[212:215]
    ds_read_b64_tr_b16 a[190:191], v42 offset:15424
    v_mfma_f32_16x16x32_bf16 v[208:211], a[152:155], a[8:11], v[208:211]
    ds_read_b64_tr_b16 a[192:193], v43 offset:41024
    v_mfma_f32_16x16x32_bf16 v[212:215], a[152:155], a[12:15], v[212:215]
    ds_read_b64_tr_b16 a[194:195], v43 offset:46144
    v_mfma_f32_16x16x32_bf16 v[208:211], a[156:159], a[16:19], v[208:211]
    ds_read_b64_tr_b16 a[196:197], v43 offset:51264
    v_mfma_f32_16x16x32_bf16 v[212:215], a[156:159], a[20:23], v[212:215]
    ds_read_b64_tr_b16 a[198:199], v43 offset:56384
    s_waitcnt lgkmcnt(8)
    v_mfma_f32_16x16x32_bf16 v[216:219], a[160:163], a[56:59], v[216:219]
    ds_read_b64_tr_b16 a[200:201], v42 offset:96
    v_mfma_f32_16x16x32_bf16 v[220:223], a[160:163], a[60:63], v[220:223]
    ds_read_b64_tr_b16 a[202:203], v42 offset:5216
    v_mfma_f32_16x16x32_bf16 v[216:219], a[164:167], a[0:3], v[216:219]
    ds_read_b64_tr_b16 a[204:205], v42 offset:10336
    v_mfma_f32_16x16x32_bf16 v[220:223], a[164:167], a[4:7], v[220:223]
    ds_read_b64_tr_b16 a[206:207], v42 offset:15456
    v_mfma_f32_16x16x32_bf16 v[216:219], a[168:171], a[8:11], v[216:219]
    ds_read_b64_tr_b16 a[208:209], v43 offset:41056
    v_mfma_f32_16x16x32_bf16 v[220:223], a[168:171], a[12:15], v[220:223]
    ds_read_b64_tr_b16 a[210:211], v43 offset:46176
    v_mfma_f32_16x16x32_bf16 v[216:219], a[172:175], a[16:19], v[216:219]
    ds_read_b64_tr_b16 a[212:213], v43 offset:51296
    v_mfma_f32_16x16x32_bf16 v[220:223], a[172:175], a[20:23], v[220:223]
    ds_read_b64_tr_b16 a[214:215], v43 offset:56416
    s_waitcnt lgkmcnt(8)
    v_mfma_f32_16x16x32_bf16 v[224:227], a[184:187], a[56:59], v[224:227]
    ds_read_b64_tr_b16 a[144:145], v42 offset:128
    v_mfma_f32_16x16x32_bf16 v[228:231], a[184:187], a[60:63], v[228:231]
    ds_read_b64_tr_b16 a[146:147], v42 offset:5248
    v_mfma_f32_16x16x32_bf16 v[224:227], a[188:191], a[0:3], v[224:227]
    ds_read_b64_tr_b16 a[148:149], v42 offset:10368
    v_mfma_f32_16x16x32_bf16 v[228:231], a[188:191], a[4:7], v[228:231]
    ds_read_b64_tr_b16 a[150:151], v42 offset:15488
    v_mfma_f32_16x16x32_bf16 v[224:227], a[192:195], a[8:11], v[224:227]
    ds_read_b64_tr_b16 a[152:153], v43 offset:41088
    v_mfma_f32_16x16x32_bf16 v[228:231], a[192:195], a[12:15], v[228:231]
    ds_read_b64_tr_b16 a[154:155], v43 offset:46208
    v_mfma_f32_16x16x32_bf16 v[224:227], a[196:199], a[16:19], v[224:227]
    ds_read_b64_tr_b16 a[156:157], v43 offset:51328
    v_mfma_f32_16x16x32_bf16 v[228:231], a[196:199], a[20:23], v[228:231]
    ds_read_b64_tr_b16 a[158:159], v43 offset:56448
    s_waitcnt lgkmcnt(8)
    v_mfma_f32_16x16x32_bf16 v[232:235], a[200:203], a[56:59], v[232:235]
    ds_read_b64_tr_b16 a[160:161], v42 offset:160
    v_mfma_f32_16x16x32_bf16 v[236:239], a[200:203], a[60:63], v[236:239]
    ds_read_b64_tr_b16 a[162:163], v42 offset:5280
    v_mfma_f32_16x16x32_bf16 v[232:235], a[204:207], a[0:3], v[232:235]
    ds_read_b64_tr_b16 a[164:165], v42 offset:10400
    v_mfma_f32_16x16x32_bf16 v[236:239], a[204:207], a[4:7], v[236:239]
    ds_read_b64_tr_b16 a[166:167], v42 offset:15520
    v_mfma_f32_16x16x32_bf16 v[232:235], a[208:211], a[8:11], v[232:235]
    ds_read_b64_tr_b16 a[168:169], v43 offset:41120
    v_mfma_f32_16x16x32_bf16 v[236:239], a[208:211], a[12:15], v[236:239]
    ds_read_b64_tr_b16 a[170:171], v43 offset:46240
    v_mfma_f32_16x16x32_bf16 v[232:235], a[212:215], a[16:19], v[232:235]
    ds_read_b64_tr_b16 a[172:173], v43 offset:51360
    v_mfma_f32_16x16x32_bf16 v[236:239], a[212:215], a[20:23], v[236:239]
    ds_read_b64_tr_b16 a[174:175], v43 offset:56480
    s_waitcnt lgkmcnt(8)
    v_mfma_f32_16x16x32_bf16 v[240:243], a[144:147], a[56:59], v[240:243]
    ds_read_b64_tr_b16 a[184:185], v42 offset:192
    v_mfma_f32_16x16x32_bf16 v[244:247], a[144:147], a[60:63], v[244:247]
    ds_read_b64_tr_b16 a[186:187], v42 offset:5312
    v_mfma_f32_16x16x32_bf16 v[240:243], a[148:151], a[0:3], v[240:243]
    ds_read_b64_tr_b16 a[188:189], v42 offset:10432
    v_mfma_f32_16x16x32_bf16 v[244:247], a[148:151], a[4:7], v[244:247]
    ds_read_b64_tr_b16 a[190:191], v42 offset:15552
    v_mfma_f32_16x16x32_bf16 v[240:243], a[152:155], a[8:11], v[240:243]
    ds_read_b64_tr_b16 a[192:193], v43 offset:41152
    v_mfma_f32_16x16x32_bf16 v[244:247], a[152:155], a[12:15], v[244:247]
    ds_read_b64_tr_b16 a[194:195], v43 offset:46272
    v_mfma_f32_16x16x32_bf16 v[240:243], a[156:159], a[16:19], v[240:243]
    ds_read_b64_tr_b16 a[196:197], v43 offset:51392
    v_mfma_f32_16x16x32_bf16 v[244:247], a[156:159], a[20:23], v[244:247]
    ds_read_b64_tr_b16 a[198:199], v43 offset:56512
    s_waitcnt lgkmcnt(8)
    v_mfma_f32_16x16x32_bf16 v[72:75], a[160:163], a[56:59], v[72:75]
    ds_read_b64_tr_b16 a[200:201], v42 offset:224
    v_mfma_f32_16x16x32_bf16 v[76:79], a[160:163], a[60:63], v[76:79]
    ds_read_b64_tr_b16 a[202:203], v42 offset:5344
    v_mfma_f32_16x16x32_bf16 v[72:75], a[164:167], a[0:3], v[72:75]
    ds_read_b64_tr_b16 a[204:205], v42 offset:10464
    v_mfma_f32_16x16x32_bf16 v[76:79], a[164:167], a[4:7], v[76:79]
    ds_read_b64_tr_b16 a[206:207], v42 offset:15584
    v_mfma_f32_16x16x32_bf16 v[72:75], a[168:171], a[8:11], v[72:75]
    ds_read_b64_tr_b16 a[208:209], v43 offset:41184
    v_mfma_f32_16x16x32_bf16 v[76:79], a[168:171], a[12:15], v[76:79]
    ds_read_b64_tr_b16 a[210:211], v43 offset:46304
    v_mfma_f32_16x16x32_bf16 v[72:75], a[172:175], a[16:19], v[72:75]
    ds_read_b64_tr_b16 a[212:213], v43 offset:51424
    v_mfma_f32_16x16x32_bf16 v[76:79], a[172:175], a[20:23], v[76:79]
    ds_read_b64_tr_b16 a[214:215], v43 offset:56544
    s_waitcnt lgkmcnt(8)
    v_mfma_f32_16x16x32_bf16 v[88:91], a[184:187], a[56:59], v[88:91]
    ds_read_b64_tr_b16 a[144:145], v42 offset:256
    v_mfma_f32_16x16x32_bf16 v[92:95], a[184:187], a[60:63], v[92:95]
    ds_read_b64_tr_b16 a[146:147], v42 offset:5376
    v_mfma_f32_16x16x32_bf16 v[88:91], a[188:191], a[0:3], v[88:91]
    ds_read_b64_tr_b16 a[148:149], v42 offset:10496
    v_mfma_f32_16x16x32_bf16 v[92:95], a[188:191], a[4:7], v[92:95]
    ds_read_b64_tr_b16 a[150:151], v42 offset:15616
    v_mfma_f32_16x16x32_bf16 v[88:91], a[192:195], a[8:11], v[88:91]
    ds_read_b64_tr_b16 a[152:153], v43 offset:41216
    v_mfma_f32_16x16x32_bf16 v[92:95], a[192:195], a[12:15], v[92:95]
    ds_read_b64_tr_b16 a[154:155], v43 offset:46336
    v_mfma_f32_16x16x32_bf16 v[88:91], a[196:199], a[16:19], v[88:91]
    ds_read_b64_tr_b16 a[156:157], v43 offset:51456
    v_mfma_f32_16x16x32_bf16 v[92:95], a[196:199], a[20:23], v[92:95]
    ds_read_b64_tr_b16 a[158:159], v43 offset:56576
    s_waitcnt lgkmcnt(8)
    v_mfma_f32_16x16x32_bf16 v[104:107], a[200:203], a[56:59], v[104:107]
    v_mfma_f32_16x16x32_bf16 v[108:111], a[200:203], a[60:63], v[108:111]
    v_mfma_f32_16x16x32_bf16 v[104:107], a[204:207], a[0:3], v[104:107]
    v_mfma_f32_16x16x32_bf16 v[108:111], a[204:207], a[4:7], v[108:111]
    v_mfma_f32_16x16x32_bf16 v[104:107], a[208:211], a[8:11], v[104:107]
    v_mfma_f32_16x16x32_bf16 v[108:111], a[208:211], a[12:15], v[108:111]
    v_mfma_f32_16x16x32_bf16 v[104:107], a[212:215], a[16:19], v[104:107]
    v_mfma_f32_16x16x32_bf16 v[108:111], a[212:215], a[20:23], v[108:111]
    s_waitcnt lgkmcnt(0)
    v_mfma_f32_16x16x32_bf16 v[120:123], a[144:147], a[56:59], v[120:123]
    v_mfma_f32_16x16x32_bf16 v[124:127], a[144:147], a[60:63], v[124:127]
    v_mfma_f32_16x16x32_bf16 v[120:123], a[148:151], a[0:3], v[120:123]
    v_mfma_f32_16x16x32_bf16 v[124:127], a[148:151], a[4:7], v[124:127]
    v_mfma_f32_16x16x32_bf16 v[120:123], a[152:155], a[8:11], v[120:123]
    v_mfma_f32_16x16x32_bf16 v[124:127], a[152:155], a[12:15], v[124:127]
    v_mfma_f32_16x16x32_bf16 v[120:123], a[156:159], a[16:19], v[120:123]
    v_mfma_f32_16x16x32_bf16 v[124:127], a[156:159], a[20:23], v[124:127]
    v_add_u32 v59, 61440, v53
    v_accvgpr_read_b32 v60, a224
    v_accvgpr_read_b32 v61, a225
    v_lshlrev_b32 v49, 16, v60
    v_and_b32 v60, 0xffff0000, v60
    v_lshlrev_b32 v50, 16, v61
    v_and_b32 v61, 0xffff0000, v61
    v_add_f32 v208, v208, v49
    v_add_f32 v209, v209, v60
    v_add_f32 v210, v210, v50
    v_add_f32 v211, v211, v61
    ds_write_b128 v59, v[208:211] offset:0
    v_add_f32 v212, v212, v49
    v_add_f32 v213, v213, v60
    v_add_f32 v214, v214, v50
    v_add_f32 v215, v215, v61
    ds_write_b128 v59, v[212:215] offset:1024
    v_accvgpr_read_b32 v60, a226
    v_accvgpr_read_b32 v61, a227
    v_lshlrev_b32 v49, 16, v60
    v_and_b32 v60, 0xffff0000, v60
    v_lshlrev_b32 v50, 16, v61
    v_and_b32 v61, 0xffff0000, v61
    v_add_f32 v216, v216, v49
    v_add_f32 v217, v217, v60
    v_add_f32 v218, v218, v50
    v_add_f32 v219, v219, v61
    ds_write_b128 v59, v[216:219] offset:2048
    v_add_f32 v220, v220, v49
    v_add_f32 v221, v221, v60
    v_add_f32 v222, v222, v50
    v_add_f32 v223, v223, v61
    ds_write_b128 v59, v[220:223] offset:3072
    v_accvgpr_read_b32 v60, a228
    v_accvgpr_read_b32 v61, a229
    v_lshlrev_b32 v49, 16, v60
    v_and_b32 v60, 0xffff0000, v60
    v_lshlrev_b32 v50, 16, v61
    v_and_b32 v61, 0xffff0000, v61
    v_add_f32 v224, v224, v49
    v_add_f32 v225, v225, v60
    v_add_f32 v226, v226, v50
    v_add_f32 v227, v227, v61
    ds_write_b128 v59, v[224:227] offset:4096
    v_add_f32 v228, v228, v49
    v_add_f32 v229, v229, v60
    v_add_f32 v230, v230, v50
    v_add_f32 v231, v231, v61
    ds_write_b128 v59, v[228:231] offset:5120
    v_accvgpr_read_b32 v60, a230
    v_accvgpr_read_b32 v61, a231
    v_lshlrev_b32 v49, 16, v60
    v_and_b32 v60, 0xffff0000, v60
    v_lshlrev_b32 v50, 16, v61
    v_and_b32 v61, 0xffff0000, v61
    v_add_f32 v232, v232, v49
    v_add_f32 v233, v233, v60
    v_add_f32 v234, v234, v50
    v_add_f32 v235, v235, v61
    ds_write_b128 v59, v[232:235] offset:6144
    v_add_f32 v236, v236, v49
    v_add_f32 v237, v237, v60
    v_add_f32 v238, v238, v50
    v_add_f32 v239, v239, v61
    ds_write_b128 v59, v[236:239] offset:7168
    v_accvgpr_read_b32 v60, a232
    v_accvgpr_read_b32 v61, a233
    v_lshlrev_b32 v49, 16, v60
    v_and_b32 v60, 0xffff0000, v60
    v_lshlrev_b32 v50, 16, v61
    v_and_b32 v61, 0xffff0000, v61
    v_add_f32 v240, v240, v49
    v_add_f32 v241, v241, v60
    v_add_f32 v242, v242, v50
    v_add_f32 v243, v243, v61
    ds_write_b128 v59, v[240:243] offset:8192
    v_add_f32 v244, v244, v49
    v_add_f32 v245, v245, v60
    v_add_f32 v246, v246, v50
    v_add_f32 v247, v247, v61
    ds_write_b128 v59, v[244:247] offset:9216
    v_accvgpr_read_b32 v60, a234
    v_accvgpr_read_b32 v61, a235
    v_lshlrev_b32 v49, 16, v60
    v_and_b32 v60, 0xffff0000, v60
    v_lshlrev_b32 v50, 16, v61
    v_and_b32 v61, 0xffff0000, v61
    v_add_f32 v72, v72, v49
    v_add_f32 v73, v73, v60
    v_add_f32 v74, v74, v50
    v_add_f32 v75, v75, v61
    ds_write_b128 v59, v[72:75] offset:10240
    v_add_f32 v76, v76, v49
    v_add_f32 v77, v77, v60
    v_add_f32 v78, v78, v50
    v_add_f32 v79, v79, v61
    ds_write_b128 v59, v[76:79] offset:11264
    v_accvgpr_read_b32 v60, a236
    v_accvgpr_read_b32 v61, a237
    v_lshlrev_b32 v49, 16, v60
    v_and_b32 v60, 0xffff0000, v60
    v_lshlrev_b32 v50, 16, v61
    v_and_b32 v61, 0xffff0000, v61
    v_add_f32 v88, v88, v49
    v_add_f32 v89, v89, v60
    v_add_f32 v90, v90, v50
    v_add_f32 v91, v91, v61
    ds_write_b128 v59, v[88:91] offset:12288
    v_add_f32 v92, v92, v49
    v_add_f32 v93, v93, v60
    v_add_f32 v94, v94, v50
    v_add_f32 v95, v95, v61
    ds_write_b128 v59, v[92:95] offset:13312
    v_accvgpr_read_b32 v60, a238
    v_accvgpr_read_b32 v61, a239
    v_lshlrev_b32 v49, 16, v60
    v_and_b32 v60, 0xffff0000, v60
    v_lshlrev_b32 v50, 16, v61
    v_and_b32 v61, 0xffff0000, v61
    v_add_f32 v104, v104, v49
    v_add_f32 v105, v105, v60
    v_add_f32 v106, v106, v50
    v_add_f32 v107, v107, v61
    ds_write_b128 v59, v[104:107] offset:14336
    v_add_f32 v108, v108, v49
    v_add_f32 v109, v109, v60
    v_add_f32 v110, v110, v50
    v_add_f32 v111, v111, v61
    ds_write_b128 v59, v[108:111] offset:15360
    v_accvgpr_read_b32 v60, a240
    v_accvgpr_read_b32 v61, a241
    v_lshlrev_b32 v49, 16, v60
    v_and_b32 v60, 0xffff0000, v60
    v_lshlrev_b32 v50, 16, v61
    v_and_b32 v61, 0xffff0000, v61
    s_nop 3
    v_add_f32 v120, v120, v49
    v_add_f32 v121, v121, v60
    v_add_f32 v122, v122, v50
    v_add_f32 v123, v123, v61
    ds_write_b128 v59, v[120:123] offset:16384
    v_add_f32 v124, v124, v49
    v_add_f32 v125, v125, v60
    v_add_f32 v126, v126, v50
    v_add_f32 v127, v127, v61
    ds_write_b128 v59, v[124:127] offset:17408
    v_mov_b32 v60, 79872
    v_mov_b32 v61, 0
    ds_write_b32 v60, v61
    s_waitcnt lgkmcnt(0)
    s_barrier
    s_branch L_end
L_code_end:
.section .rodata,"a"
.p2align 6
.amdhsa_kernel standalone__dense_activation_squared_relu__prompt_kernel
  .amdhsa_next_free_vgpr 512
  .amdhsa_next_free_sgpr 102
  .amdhsa_accum_offset 256
  .amdhsa_group_segment_fixed_size 0
  .amdhsa_kernarg_size 64
  .amdhsa_user_sgpr_count 2
  .amdhsa_user_sgpr_kernarg_segment_ptr 1
  .amdhsa_system_sgpr_workgroup_id_x 1
.end_amdhsa_kernel
```
